```python
import torch

def _softmax(x, axis=-1):
    return torch.softmax(x, dim=axis)
def _gelu(x):
    return torch.nn.functional.gelu(x, approximate="tanh")
def _silu(x):
    return torch.nn.functional.silu(x)
def _sigmoid(x):
    return torch.sigmoid(x)
def _layernorm(x, axis=-1, eps=1e-5):
    m = x.mean(dim=axis, keepdim=True)
    v = x.var(dim=axis, keepdim=True, unbiased=False)
    return (x - m) / torch.sqrt(v + eps)
def _scatter_add(tgt, idx, src, axis=0):
    return tgt.clone().index_add_(axis, idx, src)
def _segment_sum(src, seg, n):
    out = torch.zeros((n,) + src.shape[1:], dtype=src.dtype)
    return out.index_add_(0, seg, src)
def _pad(x, pw):
    flat = tuple(v for pair in reversed(pw) for v in pair)
    return torch.nn.functional.pad(x, flat)

kernel_name = 'standalone__detection_seg_dino__vision'

def setup_inputs():

    _w = (lambda a: (lambda t: t.to(torch.bfloat16) if t.is_floating_point() else t)(torch.as_tensor(a)))
    H = W = (384 // 2) * 2
    C = 384
    Nq = 16
    sc = C ** -0.5
    return {
        "q": _w((lambda *s: torch.randn(*s, dtype=torch.bfloat16) * 0.05)(1, Nq, C)),
        "f0": _w((lambda *s: torch.randn(*s, dtype=torch.bfloat16) * 0.8)(1, H, W, C)),
        "f1": _w((lambda *s: torch.randn(*s, dtype=torch.bfloat16) * 0.8)(1, H // 2, W // 2, C)),
        "wq": _w((lambda *s: torch.randn(*s, dtype=torch.bfloat16) * 1.6)(C, C) * sc),
        "wk": _w((lambda *s: torch.randn(*s, dtype=torch.bfloat16) * 1.6)(C, C) * sc),
        "wv": _w((lambda *s: torch.randn(*s, dtype=torch.bfloat16) * 0.8)(C, C) * sc),
        "wo": _w((lambda *s: torch.randn(*s, dtype=torch.bfloat16) * 0.8)(C, C) * sc),
    }

def reference(q, f0, f1, wq, wk, wv, wo):
    B, H, W, C = f0.shape
    f1u = (lambda x, n, axis: torch.repeat_interleave(x, n, dim=axis))((lambda x, n, axis: torch.repeat_interleave(x, n, dim=axis))(f1, 2, axis=1), 2, axis=2)
    fused = f0 + f1u
    feats = _layernorm(fused.reshape(B, H * W, C), axis=-1)
    qn = _layernorm(q, axis=-1)
    Q = torch.einsum("bnc,cd->bnd", qn, wq)
    K = torch.einsum("bmc,cd->bmd", feats, wk)
    V = torch.einsum("bmc,cd->bmd", feats, wv)
    scale = C ** -0.5
    logits = torch.einsum("bnd,bmd->bnm", Q, K) * scale
    attn = _softmax(logits, axis=-1)
    ctx = torch.einsum("bnm,bmd->bnd", attn, V)
    return q + torch.einsum("bnd,dc->bnc", ctx, wo)
```

```asm
; @launch grid=(256,1,1) block=(256,1,1) lds=163392
.amdgcn_target "amdgcn-amd-amdhsa--gfx950"
.text
.globl standalone__detection_seg_dino__vision_kernel
.p2align 8
.type standalone__detection_seg_dino__vision_kernel,@function
standalone__detection_seg_dino__vision_kernel:
    s_cmp_ge_u32 s2, 256
    s_cbranch_scc1 K_END
    s_load_dwordx4 s[4:7], s[0:1], 8
    s_load_dwordx2 s[8:9], s[0:1], 72
    s_load_dwordx2 s[54:55], s[0:1], 0
    s_load_dwordx8 s[64:71], s[0:1], 24
    s_load_dwordx2 s[58:59], s[0:1], 56
    s_mov_b32 s17, s2
    s_mov_b32 s60, 0
    v_and_b32 v216, 63, v0
    v_lshrrev_b32 v1, 6, v0
    v_lshlrev_b32 v223, 4, v216
    v_readfirstlane_b32 s16, v1
    v_lshrrev_b32 v2, 4, v216
    v_and_b32 v3, 15, v216
    v_lshlrev_b32 v4, 4, v3
    v_mul_u32_u24 v5, 1536, v2
    v_add_u32 v207, v5, v4
    v_mul_u32_u24 v5, 768, v2
    v_add_u32 v208, v5, v4
    s_mul_i32 s19, s17, 36
    s_add_u32 s19, s19, s16
    s_mov_b32 s52, 0
    s_mov_b32 s53, 0
    s_and_b32 s74, s2, 7
    s_lshr_b32 s34, s2, 3
    s_cmp_lt_u32 s74, 2
    s_cbranch_scc1 ROLE_S
    s_cmp_eq_u32 s74, 4
    s_cbranch_scc1 ROLE_G
    s_cmp_eq_u32 s74, 7
    s_cbranch_scc1 ROLE_DONE
    s_cmp_ge_u32 s74, 5
    s_cselect_b32 s35, 3, 2
    s_sub_u32 s35, s74, s35
    s_lshl_b32 s35, s35, 5
    s_add_u32 s53, s35, s34
    s_mov_b32 s52, 5
    s_branch ROLE_DONE
ROLE_S:
    s_cmp_ge_u32 s34, 24
    s_cbranch_scc1 ROLE_DONE
    s_mov_b32 s53, s34
    s_mov_b32 s52, 1
    s_cmp_ge_u32 s34, 12
    s_cbranch_scc0 ROLE_DONE
    s_mul_i32 s35, s74, 12
    s_add_u32 s53, s34, s35
    s_sub_u32 s53, s53, 12
    s_mov_b32 s52, 2
    s_branch ROLE_DONE
ROLE_G:
    s_cmp_ge_u32 s34, 24
    s_cbranch_scc1 ROLE_DONE
    s_mov_b32 s53, s34
    s_mov_b32 s52, 3
    s_cmp_ge_u32 s34, 12
    s_cbranch_scc0 ROLE_DONE
    s_sub_u32 s53, s34, 12
    s_mov_b32 s52, 4
ROLE_DONE:
    s_waitcnt lgkmcnt(0)
    s_load_dword s51, s[8:9], 0
    s_cmp_eq_u32 s52, 1
    s_cbranch_scc0 P2_1
    s_mul_i32 s36, s16, 192
    v_add_u32 v128, 0, v216
    v_mul_u32_u24 v129, 43691, v128
    v_lshrrev_b32 v129, 19, v129
    v_mul_u32_u24 v130, 12, v129
    v_sub_u32 v130, v128, v130
    v_lshlrev_b32 v130, 4, v130
    v_mul_u32_u24 v129, 768, v129
    v_add3_u32 v2, v129, v130, s36
    v_add_u32 v128, 64, v216
    v_mul_u32_u24 v129, 43691, v128
    v_lshrrev_b32 v129, 19, v129
    v_mul_u32_u24 v130, 12, v129
    v_sub_u32 v130, v128, v130
    v_lshlrev_b32 v130, 4, v130
    v_mul_u32_u24 v129, 768, v129
    v_add3_u32 v3, v129, v130, s36
    v_add_u32 v128, 128, v216
    v_mul_u32_u24 v129, 43691, v128
    v_lshrrev_b32 v129, 19, v129
    v_mul_u32_u24 v130, 12, v129
    v_sub_u32 v130, v128, v130
    v_lshlrev_b32 v130, 4, v130
    v_mul_u32_u24 v129, 768, v129
    v_add3_u32 v4, v129, v130, s36
    global_load_dwordx4 v[236:239], v2, s[54:55]
    global_load_dwordx4 v[240:243], v3, s[54:55]
    global_load_dwordx4 v[244:247], v4, s[54:55]
    v_lshrrev_b32 v1, 2, v216
    s_mul_i32 s34, s16, 96
    v_add_u32 v1, s34, v1
    v_and_b32 v128, 3, v216
    v_lshlrev_b32 v128, 4, v128
    s_lshl_b32 s34, s53, 6
    v_add_u32 v128, s34, v128
    v_add_u32 v2, 0, v1
    v_mul_u32_u24 v2, 768, v2
    v_add_u32 v2, v2, v128
    v_add_u32 v3, 16, v1
    v_mul_u32_u24 v3, 768, v3
    v_add_u32 v3, v3, v128
    v_add_u32 v4, 32, v1
    v_mul_u32_u24 v4, 768, v4
    v_add_u32 v4, v4, v128
    v_add_u32 v5, 48, v1
    v_mul_u32_u24 v5, 768, v5
    v_add_u32 v5, v5, v128
    v_add_u32 v6, 64, v1
    v_mul_u32_u24 v6, 768, v6
    v_add_u32 v6, v6, v128
    v_add_u32 v7, 80, v1
    v_mul_u32_u24 v7, 768, v7
    v_add_u32 v7, v7, v128
    global_load_dwordx4 v[160:163], v2, s[64:65]
    global_load_dwordx4 v[164:167], v3, s[64:65]
    global_load_dwordx4 v[168:171], v4, s[64:65]
    global_load_dwordx4 v[172:175], v5, s[64:65]
    global_load_dwordx4 v[176:179], v6, s[64:65]
    global_load_dwordx4 v[180:183], v7, s[64:65]
P2_1:
    s_mul_hi_u32 s34, s19, 89478486
    s_mul_i32 s35, s34, 48
    s_sub_u32 s35, s19, s35
    s_mul_i32 s34, s34, 589824
    s_mul_i32 s35, s35, 6144
    s_add_u32 s34, s34, s35
    s_add_u32 s10, s4, s34
    s_addc_u32 s11, s5, 0
    s_add_u32 s12, s10, 294912
    s_addc_u32 s13, s11, 0
    s_mul_i32 s34, s19, 3072
    s_add_u32 s14, s6, s34
    s_addc_u32 s15, s7, 0
    s_add_u32 s19, s19, 4
    s_cmp_eq_u32 s52, 1
    s_cbranch_scc1 PH_2
    global_load_dwordx4 v[56:59], v208, s[14:15] offset:0 nt
    global_load_dwordx4 v[8:11], v207, s[10:11] offset:0 nt
    global_load_dwordx4 v[12:15], v207, s[10:11] offset:768 nt
    global_load_dwordx4 v[16:19], v207, s[12:13] offset:0 nt
    global_load_dwordx4 v[20:23], v207, s[12:13] offset:768 nt
    global_load_dwordx4 v[60:63], v208, s[14:15] offset:256 nt
    global_load_dwordx4 v[24:27], v207, s[10:11] offset:256 nt
    global_load_dwordx4 v[28:31], v207, s[10:11] offset:1024 nt
    global_load_dwordx4 v[32:35], v207, s[12:13] offset:256 nt
    global_load_dwordx4 v[36:39], v207, s[12:13] offset:1024 nt
PH_2:
    s_sub_u32 s34, s17, 192
    s_cmp_lt_u32 s34, 64
    s_cbranch_scc0 CPF_3
    s_cmp_ge_u32 s16, 2
    s_cbranch_scc0 CPF_3
    s_getpc_b64 s[72:73]
CPF_PC:
    s_lshr_b32 s34, s34, 3
    s_lshl_b32 s34, s34, 1
    s_and_b32 s35, s16, 1
    s_add_u32 s34, s34, s35
    s_mul_i32 s34, s34, (((K_END - CPF_PC) / 128 + 16) / 16) * 128
    v_lshlrev_b32 v1, 7, v216
    v_add_u32 v1, s34, v1
    v_cmp_gt_u32 vcc, (((K_END - CPF_PC) / 128 + 16) / 16), v216
    v_min_u32 v1, (K_END - CPF_PC), v1
    s_and_saveexec_b64 s[62:63], vcc
    global_load_dword v248, v1, s[72:73]
    s_mov_b64 exec, s[62:63]
CPF_3:
    v_lshrrev_b32 v2, 4, v216
    v_and_b32 v3, 15, v216
    s_mul_i32 s34, s16, 12288
    v_lshlrev_b32 v5, 2, v2
    v_add_u32 v5, v5, v3
    v_and_b32 v5, 15, v5
    v_lshlrev_b32 v5, 4, v5
    v_lshlrev_b32 v6, 8, v2
    v_add_u32 v5, v5, v6
    v_add_u32 v209, s34, v5
    s_lshl_b32 s35, s16, 10
    v_add_u32 v212, s35, v5
    v_lshrrev_b32 v5, 2, v216
    v_and_b32 v5, 3, v5
    v_and_b32 v6, 3, v216
    v_lshrrev_b32 v7, 1, v2
    v_add_u32 v7, v7, v6
    v_lshlrev_b32 v7, 2, v7
    v_and_b32 v1, 1, v2
    v_lshlrev_b32 v1, 1, v1
    v_add_u32 v7, v7, v1
    v_lshrrev_b32 v1, 1, v5
    v_add_u32 v7, v7, v1
    v_and_b32 v1, 1, v5
    v_lshlrev_b32 v1, 3, v1
    v_lshlrev_b32 v6, 8, v6
    v_add3_u32 v6, v6, v1, s34
    v_and_b32 v1, 15, v7
    v_lshlrev_b32 v1, 4, v1
    v_add_u32 v210, v6, v1
    v_add_u32 v7, 8, v7
    v_and_b32 v1, 15, v7
    v_lshlrev_b32 v1, 4, v1
    v_add_u32 v211, v6, v1
    v_lshlrev_b32 v5, 3, v216
    v_add_u32 v214, 147456, v5
    s_lshl_b32 s34, s16, 9
    v_add_u32 v213, s34, v214
    v_add_u32 v255, 151552, v223
    s_lshl_b32 s34, s16, 2
    v_add_u32 v254, s34, v255
    s_mov_b32 s61, 0x41000000
    v_lshlrev_b32 v5, 2, v3
    v_add_u32 v215, 161792, v5
    v_mov_b32 v202, 0xff800000
    ds_write_b32 v215, v202
    v_lshlrev_b32 v5, 2, v2
    v_add_u32 v6, 0, v5
    v_cmp_eq_u32 s[26:27], v6, v3
    v_add_u32 v6, 1, v5
    v_cmp_eq_u32 s[28:29], v6, v3
    v_add_u32 v6, 2, v5
    v_cmp_eq_u32 s[30:31], v6, v3
    v_add_u32 v6, 3, v5
    v_cmp_eq_u32 s[32:33], v6, v3
    s_mov_b32 s20, 0x00003f80
    s_mov_b32 s21, 0x3f800000
    s_mov_b32 s23, 0x3b2aaaab
    v_mov_b32 v206, 0x3727c5ac
    v_mov_b32 v205, 1.0
    v_mov_b32 v203, 0
    v_mov_b32 v221, 0
    v_mov_b32 v252, 0
    v_mov_b32 v1, 0x3f803f80
    v_accvgpr_write_b32 a152, v1
    v_accvgpr_write_b32 a153, v1
    v_accvgpr_write_b32 a154, v1
    v_accvgpr_write_b32 a155, v1
    s_waitcnt lgkmcnt(0)
    s_mul_i32 s50, s51, 0x9E3779B1
    s_add_u32 s50, s50, 0x7F4A7C15
    s_cmp_eq_u32 s52, 1
    s_cbranch_scc0 H1_4
    s_waitcnt vmcnt(0)
    global_load_dwordx4 v[56:59], v208, s[14:15] offset:0 nt
    global_load_dwordx4 v[8:11], v207, s[10:11] offset:0 nt
    global_load_dwordx4 v[12:15], v207, s[10:11] offset:768 nt
    global_load_dwordx4 v[16:19], v207, s[12:13] offset:0 nt
    global_load_dwordx4 v[20:23], v207, s[12:13] offset:768 nt
    global_load_dwordx4 v[60:63], v208, s[14:15] offset:256 nt
    global_load_dwordx4 v[24:27], v207, s[10:11] offset:256 nt
    global_load_dwordx4 v[28:31], v207, s[10:11] offset:1024 nt
    global_load_dwordx4 v[32:35], v207, s[12:13] offset:256 nt
    global_load_dwordx4 v[36:39], v207, s[12:13] offset:1024 nt
    s_mul_i32 s34, s16, 12288
    s_add_u32 s34, s34, 106496
    v_add_u32 v1, s34, v223
    ds_write_b128 v1, v[236:239] offset:0
    ds_write_b128 v1, v[240:243] offset:1024
    ds_write_b128 v1, v[244:247] offset:2048
    v_and_b32 v2, 15, v216
    v_mul_u32_u24 v2, 192, v2
    v_lshrrev_b32 v3, 4, v216
    v_lshlrev_b32 v3, 4, v3
    v_add3_u32 v2, v2, v3, s34
    ds_read_b128 v[224:227], v2 offset:0
    ds_read_b128 v[228:231], v2 offset:64
    ds_read_b128 v[232:235], v2 offset:128
    s_mul_i32 s34, s16, 12288
    s_add_u32 s34, s34, 98304
    v_add_u32 v1, s34, v223
    ds_write_b128 v1, v[160:163] offset:0
    ds_write_b128 v1, v[164:167] offset:1024
    ds_write_b128 v1, v[168:171] offset:2048
    ds_write_b128 v1, v[172:175] offset:3072
    ds_write_b128 v1, v[176:179] offset:4096
    ds_write_b128 v1, v[180:183] offset:5120
    v_lshrrev_b32 v2, 4, v216
    v_lshlrev_b32 v2, 9, v2
    v_bfe_u32 v3, v216, 2, 2
    v_lshlrev_b32 v3, 6, v3
    v_and_b32 v4, 3, v216
    v_lshlrev_b32 v4, 4, v4
    v_add3_u32 v2, v2, v3, v4
    v_add_u32 v2, s34, v2
    ds_read_b64_tr_b16 a[156:157], v2 offset:0
    ds_read_b64_tr_b16 a[158:159], v2 offset:256
    ds_read_b64_tr_b16 a[160:161], v2 offset:8
    ds_read_b64_tr_b16 a[162:163], v2 offset:264
    ds_read_b64_tr_b16 a[164:165], v2 offset:2048
    ds_read_b64_tr_b16 a[166:167], v2 offset:2304
    ds_read_b64_tr_b16 a[168:169], v2 offset:2056
    ds_read_b64_tr_b16 a[170:171], v2 offset:2312
    ds_read_b64_tr_b16 a[172:173], v2 offset:4096
    ds_read_b64_tr_b16 a[174:175], v2 offset:4352
    ds_read_b64_tr_b16 a[176:177], v2 offset:4104
    ds_read_b64_tr_b16 a[178:179], v2 offset:4360
    s_waitcnt lgkmcnt(12)
    v_mfma_f32_16x16x32_bf16 v[192:195], v[224:227], v[224:227], 0
    v_mfma_f32_16x16x32_bf16 v[188:191], a[152:155], v[224:227], 0
    v_mfma_f32_16x16x32_bf16 v[192:195], v[228:231], v[228:231], v[192:195]
    v_mfma_f32_16x16x32_bf16 v[188:191], a[152:155], v[228:231], v[188:191]
    v_mfma_f32_16x16x32_bf16 v[192:195], v[232:235], v[232:235], v[192:195]
    v_mfma_f32_16x16x32_bf16 v[188:191], a[152:155], v[232:235], v[188:191]
    s_nop 6
    v_cndmask_b32 v128, 0, v192, s[26:27]
    v_cndmask_b32 v128, v128, v193, s[28:29]
    v_cndmask_b32 v128, v128, v194, s[30:31]
    v_cndmask_b32 v128, v128, v195, s[32:33]
    s_nop 1
    v_mfma_f32_16x16x4_f32 v[196:199], v205, v128, 0
    s_lshl_b32 s34, s16, 9
    s_add_u32 s34, s34, 104448
    v_lshlrev_b32 v1, 3, v216
    v_add_u32 v1, s34, v1
    v_and_b32 v2, 15, v216
    v_lshlrev_b32 v2, 3, v2
    v_add_u32 v2, 104448, v2
    v_mov_b32 v130, v188
    s_nop 2
    v_mov_b32 v131, v196
    ds_write_b64 v1, v[130:131]
    s_waitcnt lgkmcnt(0)
    s_barrier
    ds_read_b64 v[132:133], v2 offset:0
    ds_read_b64 v[134:135], v2 offset:512
    ds_read_b64 v[136:137], v2 offset:1024
    ds_read_b64 v[138:139], v2 offset:1536
    s_waitcnt lgkmcnt(0)
    v_add_f32 v132, v132, v134
    v_add_f32 v133, v133, v135
    v_add_f32 v136, v136, v138
    v_add_f32 v137, v137, v139
    v_add_f32 v132, v132, v136
    v_add_f32 v133, v133, v137
    v_mul_f32 v132, s23, v132
    v_mul_f32 v133, s23, v133
    v_fma_f32 v133, -v132, v132, v133
    v_max_f32 v133, 0, v133
    v_cvt_pk_bf16_f32 v134, v132, v133
    v_lshlrev_b32 v132, 16, v134
    v_and_b32 v133, 0xffff0000, v134
    v_add_f32 v133, v206, v133
    v_cvt_pk_bf16_f32 v133, v133, v133
    v_lshlrev_b32 v133, 16, v133
    v_sqrt_f32 v133, v133
    s_nop 0
    v_cvt_pk_bf16_f32 v133, v133, v133
    v_lshlrev_b32 v133, 16, v133
    v_rcp_f32 v133, v133
    v_lshlrev_b32 v136, 16, v224
    v_and_b32 v137, 0xffff0000, v224
    v_lshlrev_b32 v140, 16, v225
    v_and_b32 v141, 0xffff0000, v225
    v_sub_f32 v136, v136, v132
    v_sub_f32 v137, v137, v132
    v_sub_f32 v140, v140, v132
    v_sub_f32 v141, v141, v132
    v_cvt_pk_bf16_f32 v138, v136, v137
    v_cvt_pk_bf16_f32 v142, v140, v141
    v_lshlrev_b32 v136, 16, v138
    v_and_b32 v137, 0xffff0000, v138
    v_lshlrev_b32 v140, 16, v142
    v_and_b32 v141, 0xffff0000, v142
    v_mul_f32 v136, v136, v133
    v_mul_f32 v137, v137, v133
    v_mul_f32 v140, v140, v133
    v_mul_f32 v141, v141, v133
    v_cvt_pk_bf16_f32 v224, v136, v137
    v_cvt_pk_bf16_f32 v225, v140, v141
    v_lshlrev_b32 v136, 16, v226
    v_and_b32 v137, 0xffff0000, v226
    v_lshlrev_b32 v140, 16, v227
    v_and_b32 v141, 0xffff0000, v227
    v_sub_f32 v136, v136, v132
    v_sub_f32 v137, v137, v132
    v_sub_f32 v140, v140, v132
    v_sub_f32 v141, v141, v132
    v_cvt_pk_bf16_f32 v138, v136, v137
    v_cvt_pk_bf16_f32 v142, v140, v141
    v_lshlrev_b32 v136, 16, v138
    v_and_b32 v137, 0xffff0000, v138
    v_lshlrev_b32 v140, 16, v142
    v_and_b32 v141, 0xffff0000, v142
    v_mul_f32 v136, v136, v133
    v_mul_f32 v137, v137, v133
    v_mul_f32 v140, v140, v133
    v_mul_f32 v141, v141, v133
    v_cvt_pk_bf16_f32 v226, v136, v137
    v_cvt_pk_bf16_f32 v227, v140, v141
    v_lshlrev_b32 v136, 16, v228
    v_and_b32 v137, 0xffff0000, v228
    v_lshlrev_b32 v140, 16, v229
    v_and_b32 v141, 0xffff0000, v229
    v_sub_f32 v136, v136, v132
    v_sub_f32 v137, v137, v132
    v_sub_f32 v140, v140, v132
    v_sub_f32 v141, v141, v132
    v_cvt_pk_bf16_f32 v138, v136, v137
    v_cvt_pk_bf16_f32 v142, v140, v141
    v_lshlrev_b32 v136, 16, v138
    v_and_b32 v137, 0xffff0000, v138
    v_lshlrev_b32 v140, 16, v142
    v_and_b32 v141, 0xffff0000, v142
    v_mul_f32 v136, v136, v133
    v_mul_f32 v137, v137, v133
    v_mul_f32 v140, v140, v133
    v_mul_f32 v141, v141, v133
    v_cvt_pk_bf16_f32 v228, v136, v137
    v_cvt_pk_bf16_f32 v229, v140, v141
    v_lshlrev_b32 v136, 16, v230
    v_and_b32 v137, 0xffff0000, v230
    v_lshlrev_b32 v140, 16, v231
    v_and_b32 v141, 0xffff0000, v231
    v_sub_f32 v136, v136, v132
    v_sub_f32 v137, v137, v132
    v_sub_f32 v140, v140, v132
    v_sub_f32 v141, v141, v132
    v_cvt_pk_bf16_f32 v138, v136, v137
    v_cvt_pk_bf16_f32 v142, v140, v141
    v_lshlrev_b32 v136, 16, v138
    v_and_b32 v137, 0xffff0000, v138
    v_lshlrev_b32 v140, 16, v142
    v_and_b32 v141, 0xffff0000, v142
    v_mul_f32 v136, v136, v133
    v_mul_f32 v137, v137, v133
    v_mul_f32 v140, v140, v133
    v_mul_f32 v141, v141, v133
    v_cvt_pk_bf16_f32 v230, v136, v137
    v_cvt_pk_bf16_f32 v231, v140, v141
    v_lshlrev_b32 v136, 16, v232
    v_and_b32 v137, 0xffff0000, v232
    v_lshlrev_b32 v140, 16, v233
    v_and_b32 v141, 0xffff0000, v233
    v_sub_f32 v136, v136, v132
    v_sub_f32 v137, v137, v132
    v_sub_f32 v140, v140, v132
    v_sub_f32 v141, v141, v132
    v_cvt_pk_bf16_f32 v138, v136, v137
    v_cvt_pk_bf16_f32 v142, v140, v141
    v_lshlrev_b32 v136, 16, v138
    v_and_b32 v137, 0xffff0000, v138
    v_lshlrev_b32 v140, 16, v142
    v_and_b32 v141, 0xffff0000, v142
    v_mul_f32 v136, v136, v133
    v_mul_f32 v137, v137, v133
    v_mul_f32 v140, v140, v133
    v_mul_f32 v141, v141, v133
    v_cvt_pk_bf16_f32 v232, v136, v137
    v_cvt_pk_bf16_f32 v233, v140, v141
    v_lshlrev_b32 v136, 16, v234
    v_and_b32 v137, 0xffff0000, v234
    v_lshlrev_b32 v140, 16, v235
    v_and_b32 v141, 0xffff0000, v235
    v_sub_f32 v136, v136, v132
    v_sub_f32 v137, v137, v132
    v_sub_f32 v140, v140, v132
    v_sub_f32 v141, v141, v132
    v_cvt_pk_bf16_f32 v138, v136, v137
    v_cvt_pk_bf16_f32 v142, v140, v141
    v_lshlrev_b32 v136, 16, v138
    v_and_b32 v137, 0xffff0000, v138
    v_lshlrev_b32 v140, 16, v142
    v_and_b32 v141, 0xffff0000, v142
    v_mul_f32 v136, v136, v133
    v_mul_f32 v137, v137, v133
    v_mul_f32 v140, v140, v133
    v_mul_f32 v141, v141, v133
    v_cvt_pk_bf16_f32 v234, v136, v137
    v_cvt_pk_bf16_f32 v235, v140, v141
    s_nop 1
    v_mfma_f32_16x16x32_bf16 v[184:187], a[156:159], v[224:227], 0
    v_mfma_f32_16x16x32_bf16 v[188:191], a[160:163], v[224:227], 0
    v_mfma_f32_16x16x32_bf16 v[184:187], a[164:167], v[228:231], v[184:187]
    v_mfma_f32_16x16x32_bf16 v[188:191], a[168:171], v[228:231], v[188:191]
    v_mfma_f32_16x16x32_bf16 v[184:187], a[172:175], v[232:235], v[184:187]
    v_mfma_f32_16x16x32_bf16 v[188:191], a[176:179], v[232:235], v[188:191]
    s_nop 7
    s_cmp_eq_u32 s16, 0
    s_cbranch_scc1 XW0_8
    s_sub_u32 s34, s16, 1
    s_lshl_b32 s34, s34, 11
    s_add_u32 s34, s34, 98304
    v_add_u32 v1, s34, v223
    ds_write_b128 v1, v[184:187]
    ds_write_b128 v1, v[188:191] offset:1024
    s_waitcnt lgkmcnt(0)
XW0_8:
    s_barrier
    s_cmp_eq_u32 s16, 0
    s_cbranch_scc0 XW_7
    v_add_u32 v1, 98304, v223
    ds_read_b128 v[128:131], v1 offset:0
    ds_read_b128 v[132:135], v1 offset:1024
    ds_read_b128 v[136:139], v1 offset:2048
    ds_read_b128 v[140:143], v1 offset:3072
    ds_read_b128 v[144:147], v1 offset:4096
    ds_read_b128 v[148:151], v1 offset:5120
    s_waitcnt lgkmcnt(4)
    v_add_f32 v184, v184, v128
    v_add_f32 v185, v185, v129
    v_add_f32 v186, v186, v130
    v_add_f32 v187, v187, v131
    v_add_f32 v188, v188, v132
    v_add_f32 v189, v189, v133
    v_add_f32 v190, v190, v134
    v_add_f32 v191, v191, v135
    s_waitcnt lgkmcnt(2)
    v_add_f32 v184, v184, v136
    v_add_f32 v185, v185, v137
    v_add_f32 v186, v186, v138
    v_add_f32 v187, v187, v139
    v_add_f32 v188, v188, v140
    v_add_f32 v189, v189, v141
    v_add_f32 v190, v190, v142
    v_add_f32 v191, v191, v143
    s_waitcnt lgkmcnt(0)
    v_add_f32 v184, v184, v144
    v_add_f32 v185, v185, v145
    v_add_f32 v186, v186, v146
    v_add_f32 v187, v187, v147
    v_add_f32 v188, v188, v148
    v_add_f32 v189, v189, v149
    v_add_f32 v190, v190, v150
    v_add_f32 v191, v191, v151
    v_cvt_pk_bf16_f32 v130, v184, v185
    v_cvt_pk_bf16_f32 v131, v186, v187
    v_cvt_pk_bf16_f32 v132, v188, v189
    v_cvt_pk_bf16_f32 v133, v190, v191
    s_lshl_b32 s34, s53, 11
    s_lshl_b32 s35, s74, 15
    s_add_u32 s34, s34, s35
    s_add_u32 s34, s34, 262144
    v_mov_b32 v128, s50
    v_mov_b32 v129, 0
    v_mov_b32 v134, s50
    v_mov_b32 v135, 0
    v_add_u32 v1, s34, v223
    v_add_u32 v2, 65536, v1
    global_store_dwordx4 v1, v[128:131], s[8:9]
    global_store_dwordx4 v1, v[132:135], s[8:9] offset:1024
    global_store_dwordx4 v2, v[128:131], s[8:9] sc1
    global_store_dwordx4 v2, v[132:135], s[8:9] offset:1024 sc1
XW_7:
    s_branch H2_5
H1_4:
    s_cmp_eq_u32 s52, 2
    s_cbranch_scc0 H2_5
    s_lshr_b32 s34, s53, 3
    s_lshl_b32 s34, s34, 7
    s_bfe_u32 s35, s53, 0x20001
    s_lshl_b32 s35, s35, 1
    s_add_u32 s37, s34, s35
    s_and_b32 s35, s53, 1
    s_lshl_b32 s35, s35, 6
    s_add_u32 s37, s37, s35
    s_mul_i32 s36, s16, 192
    v_add_u32 v128, 0, v216
    v_mul_u32_u24 v129, 43691, v128
    v_lshrrev_b32 v129, 19, v129
    v_mul_u32_u24 v130, 12, v129
    v_sub_u32 v130, v128, v130
    v_lshlrev_b32 v130, 4, v130
    v_bfe_u32 v131, v129, 3, 1
    v_lshlrev_b32 v131, 2, v131
    v_bfe_u32 v132, v129, 2, 1
    v_lshlrev_b32 v132, 1, v132
    v_bfe_u32 v133, v129, 1, 1
    v_add3_u32 v131, v131, v132, v133
    v_lshlrev_b32 v131, 3, v131
    v_and_b32 v129, 1, v129
    v_add3_u32 v129, v129, v131, s37
    v_mul_u32_u24 v129, 768, v129
    v_add3_u32 v172, v129, v130, s36
    v_add_u32 v128, 64, v216
    v_mul_u32_u24 v129, 43691, v128
    v_lshrrev_b32 v129, 19, v129
    v_mul_u32_u24 v130, 12, v129
    v_sub_u32 v130, v128, v130
    v_lshlrev_b32 v130, 4, v130
    v_bfe_u32 v131, v129, 3, 1
    v_lshlrev_b32 v131, 2, v131
    v_bfe_u32 v132, v129, 2, 1
    v_lshlrev_b32 v132, 1, v132
    v_bfe_u32 v133, v129, 1, 1
    v_add3_u32 v131, v131, v132, v133
    v_lshlrev_b32 v131, 3, v131
    v_and_b32 v129, 1, v129
    v_add3_u32 v129, v129, v131, s37
    v_mul_u32_u24 v129, 768, v129
    v_add3_u32 v173, v129, v130, s36
    v_add_u32 v128, 128, v216
    v_mul_u32_u24 v129, 43691, v128
    v_lshrrev_b32 v129, 19, v129
    v_mul_u32_u24 v130, 12, v129
    v_sub_u32 v130, v128, v130
    v_lshlrev_b32 v130, 4, v130
    v_bfe_u32 v131, v129, 3, 1
    v_lshlrev_b32 v131, 2, v131
    v_bfe_u32 v132, v129, 2, 1
    v_lshlrev_b32 v132, 1, v132
    v_bfe_u32 v133, v129, 1, 1
    v_add3_u32 v131, v131, v132, v133
    v_lshlrev_b32 v131, 3, v131
    v_and_b32 v129, 1, v129
    v_add3_u32 v129, v129, v131, s37
    v_mul_u32_u24 v129, 768, v129
    v_add3_u32 v174, v129, v130, s36
    global_load_dwordx4 v[160:163], v172, s[66:67]
    global_load_dwordx4 v[164:167], v173, s[66:67]
    global_load_dwordx4 v[168:171], v174, s[66:67]
    v_add_u32 v217, 0, v209
    s_waitcnt vmcnt(8)
    v_lshlrev_b32 v136, 16, v56
    v_and_b32 v137, 0xffff0000, v56
    v_dot2_f32_bf16 v128, v8, s20, v136
    v_dot2_f32_bf16 v129, v12, s20, v136
    v_dot2_f32_bf16 v130, v16, s20, v136
    v_dot2_f32_bf16 v131, v20, s20, v136
    global_load_dwordx4 v[64:67], v208, s[14:15] offset:512 nt
    v_dot2_f32_bf16 v132, v8, s21, v137
    v_dot2_f32_bf16 v133, v12, s21, v137
    v_dot2_f32_bf16 v134, v16, s21, v137
    v_dot2_f32_bf16 v135, v20, s21, v137
    v_lshlrev_b32 v146, 16, v57
    v_and_b32 v147, 0xffff0000, v57
    v_dot2_f32_bf16 v138, v9, s20, v146
    v_cvt_pk_bf16_f32 v152, v128, v129
    v_dot2_f32_bf16 v139, v13, s20, v146
    v_cvt_pk_bf16_f32 v153, v130, v131
    v_dot2_f32_bf16 v140, v17, s20, v146
    v_cvt_pk_bf16_f32 v154, v132, v133
    v_dot2_f32_bf16 v141, v21, s20, v146
    v_cvt_pk_bf16_f32 v155, v134, v135
    ds_write_b128 v217, v[152:155] offset:0
    global_load_dwordx4 v[40:43], v207, s[10:11] offset:512 nt
    v_dot2_f32_bf16 v142, v9, s21, v147
    v_dot2_f32_bf16 v143, v13, s21, v147
    v_dot2_f32_bf16 v144, v17, s21, v147
    v_dot2_f32_bf16 v145, v21, s21, v147
    v_lshlrev_b32 v136, 16, v58
    v_and_b32 v137, 0xffff0000, v58
    v_dot2_f32_bf16 v128, v10, s20, v136
    v_cvt_pk_bf16_f32 v156, v138, v139
    v_dot2_f32_bf16 v129, v14, s20, v136
    v_cvt_pk_bf16_f32 v157, v140, v141
    v_dot2_f32_bf16 v130, v18, s20, v136
    v_cvt_pk_bf16_f32 v158, v142, v143
    v_dot2_f32_bf16 v131, v22, s20, v136
    v_cvt_pk_bf16_f32 v159, v144, v145
    ds_write_b128 v217, v[156:159] offset:1024
    global_load_dwordx4 v[44:47], v207, s[10:11] offset:1280 nt
    v_dot2_f32_bf16 v132, v10, s21, v137
    v_dot2_f32_bf16 v133, v14, s21, v137
    v_dot2_f32_bf16 v134, v18, s21, v137
    v_dot2_f32_bf16 v135, v22, s21, v137
    v_lshlrev_b32 v146, 16, v59
    v_and_b32 v147, 0xffff0000, v59
    v_dot2_f32_bf16 v138, v11, s20, v146
    v_cvt_pk_bf16_f32 v152, v128, v129
    v_dot2_f32_bf16 v139, v15, s20, v146
    v_cvt_pk_bf16_f32 v153, v130, v131
    v_dot2_f32_bf16 v140, v19, s20, v146
    v_cvt_pk_bf16_f32 v154, v132, v133
    v_dot2_f32_bf16 v141, v23, s20, v146
    v_cvt_pk_bf16_f32 v155, v134, v135
    ds_write_b128 v217, v[152:155] offset:2048
    global_load_dwordx4 v[48:51], v207, s[12:13] offset:512 nt
    v_dot2_f32_bf16 v142, v11, s21, v147
    v_dot2_f32_bf16 v143, v15, s21, v147
    v_dot2_f32_bf16 v144, v19, s21, v147
    v_dot2_f32_bf16 v145, v23, s21, v147
    s_waitcnt vmcnt(7)
    v_lshlrev_b32 v136, 16, v60
    v_and_b32 v137, 0xffff0000, v60
    v_dot2_f32_bf16 v128, v24, s20, v136
    v_cvt_pk_bf16_f32 v156, v138, v139
    v_dot2_f32_bf16 v129, v28, s20, v136
    v_cvt_pk_bf16_f32 v157, v140, v141
    v_dot2_f32_bf16 v130, v32, s20, v136
    v_cvt_pk_bf16_f32 v158, v142, v143
    v_dot2_f32_bf16 v131, v36, s20, v136
    v_cvt_pk_bf16_f32 v159, v144, v145
    ds_write_b128 v217, v[156:159] offset:3072
    global_load_dwordx4 v[52:55], v207, s[12:13] offset:1280 nt
    v_dot2_f32_bf16 v132, v24, s21, v137
    v_dot2_f32_bf16 v133, v28, s21, v137
    v_dot2_f32_bf16 v134, v32, s21, v137
    v_dot2_f32_bf16 v135, v36, s21, v137
    v_lshlrev_b32 v146, 16, v61
    v_and_b32 v147, 0xffff0000, v61
    v_dot2_f32_bf16 v138, v25, s20, v146
    v_cvt_pk_bf16_f32 v152, v128, v129
    v_dot2_f32_bf16 v139, v29, s20, v146
    v_cvt_pk_bf16_f32 v153, v130, v131
    v_dot2_f32_bf16 v140, v33, s20, v146
    v_cvt_pk_bf16_f32 v154, v132, v133
    v_dot2_f32_bf16 v141, v37, s20, v146
    v_cvt_pk_bf16_f32 v155, v134, v135
    ds_write_b128 v217, v[152:155] offset:4096
    v_dot2_f32_bf16 v142, v25, s21, v147
    v_dot2_f32_bf16 v143, v29, s21, v147
    v_dot2_f32_bf16 v144, v33, s21, v147
    v_dot2_f32_bf16 v145, v37, s21, v147
    v_lshlrev_b32 v136, 16, v62
    v_and_b32 v137, 0xffff0000, v62
    v_dot2_f32_bf16 v128, v26, s20, v136
    v_cvt_pk_bf16_f32 v156, v138, v139
    v_dot2_f32_bf16 v129, v30, s20, v136
    v_cvt_pk_bf16_f32 v157, v140, v141
    v_dot2_f32_bf16 v130, v34, s20, v136
    v_cvt_pk_bf16_f32 v158, v142, v143
    v_dot2_f32_bf16 v131, v38, s20, v136
    v_cvt_pk_bf16_f32 v159, v144, v145
    ds_write_b128 v217, v[156:159] offset:5120
    v_dot2_f32_bf16 v132, v26, s21, v137
    v_dot2_f32_bf16 v133, v30, s21, v137
    v_dot2_f32_bf16 v134, v34, s21, v137
    v_dot2_f32_bf16 v135, v38, s21, v137
    v_lshlrev_b32 v146, 16, v63
    v_and_b32 v147, 0xffff0000, v63
    v_dot2_f32_bf16 v138, v27, s20, v146
    v_cvt_pk_bf16_f32 v152, v128, v129
    v_dot2_f32_bf16 v139, v31, s20, v146
    v_cvt_pk_bf16_f32 v153, v130, v131
    v_dot2_f32_bf16 v140, v35, s20, v146
    v_cvt_pk_bf16_f32 v154, v132, v133
    v_dot2_f32_bf16 v141, v39, s20, v146
    v_cvt_pk_bf16_f32 v155, v134, v135
    ds_write_b128 v217, v[152:155] offset:6144
    v_dot2_f32_bf16 v142, v27, s21, v147
    v_dot2_f32_bf16 v143, v31, s21, v147
    v_dot2_f32_bf16 v144, v35, s21, v147
    v_dot2_f32_bf16 v145, v39, s21, v147
    s_waitcnt vmcnt(0)
    v_lshlrev_b32 v136, 16, v64
    v_and_b32 v137, 0xffff0000, v64
    v_dot2_f32_bf16 v128, v40, s20, v136
    v_cvt_pk_bf16_f32 v156, v138, v139
    v_dot2_f32_bf16 v129, v44, s20, v136
    v_cvt_pk_bf16_f32 v157, v140, v141
    v_dot2_f32_bf16 v130, v48, s20, v136
    v_cvt_pk_bf16_f32 v158, v142, v143
    v_dot2_f32_bf16 v131, v52, s20, v136
    v_cvt_pk_bf16_f32 v159, v144, v145
    ds_write_b128 v217, v[156:159] offset:7168
    v_dot2_f32_bf16 v132, v40, s21, v137
    v_dot2_f32_bf16 v133, v44, s21, v137
    v_dot2_f32_bf16 v134, v48, s21, v137
    v_dot2_f32_bf16 v135, v52, s21, v137
    v_lshlrev_b32 v146, 16, v65
    v_and_b32 v147, 0xffff0000, v65
    v_dot2_f32_bf16 v138, v41, s20, v146
    v_cvt_pk_bf16_f32 v152, v128, v129
    v_dot2_f32_bf16 v139, v45, s20, v146
    v_cvt_pk_bf16_f32 v153, v130, v131
    v_dot2_f32_bf16 v140, v49, s20, v146
    v_cvt_pk_bf16_f32 v154, v132, v133
    v_dot2_f32_bf16 v141, v53, s20, v146
    v_cvt_pk_bf16_f32 v155, v134, v135
    ds_write_b128 v217, v[152:155] offset:8192
    v_dot2_f32_bf16 v142, v41, s21, v147
    v_dot2_f32_bf16 v143, v45, s21, v147
    v_dot2_f32_bf16 v144, v49, s21, v147
    v_dot2_f32_bf16 v145, v53, s21, v147
    v_lshlrev_b32 v136, 16, v66
    v_and_b32 v137, 0xffff0000, v66
    v_dot2_f32_bf16 v128, v42, s20, v136
    v_cvt_pk_bf16_f32 v156, v138, v139
    v_dot2_f32_bf16 v129, v46, s20, v136
    v_cvt_pk_bf16_f32 v157, v140, v141
    v_dot2_f32_bf16 v130, v50, s20, v136
    v_cvt_pk_bf16_f32 v158, v142, v143
    v_dot2_f32_bf16 v131, v54, s20, v136
    v_cvt_pk_bf16_f32 v159, v144, v145
    ds_write_b128 v217, v[156:159] offset:9216
    v_dot2_f32_bf16 v132, v42, s21, v137
    v_dot2_f32_bf16 v133, v46, s21, v137
    v_dot2_f32_bf16 v134, v50, s21, v137
    v_dot2_f32_bf16 v135, v54, s21, v137
    v_lshlrev_b32 v146, 16, v67
    v_and_b32 v147, 0xffff0000, v67
    v_dot2_f32_bf16 v138, v43, s20, v146
    v_cvt_pk_bf16_f32 v152, v128, v129
    v_dot2_f32_bf16 v139, v47, s20, v146
    v_cvt_pk_bf16_f32 v153, v130, v131
    v_dot2_f32_bf16 v140, v51, s20, v146
    v_cvt_pk_bf16_f32 v154, v132, v133
    v_dot2_f32_bf16 v141, v55, s20, v146
    v_cvt_pk_bf16_f32 v155, v134, v135
    ds_write_b128 v217, v[152:155] offset:10240
    v_dot2_f32_bf16 v142, v43, s21, v147
    v_dot2_f32_bf16 v143, v47, s21, v147
    v_dot2_f32_bf16 v144, v51, s21, v147
    v_dot2_f32_bf16 v145, v55, s21, v147
    s_nop 0
    v_cvt_pk_bf16_f32 v156, v138, v139
    v_cvt_pk_bf16_f32 v157, v140, v141
    v_cvt_pk_bf16_f32 v158, v142, v143
    v_cvt_pk_bf16_f32 v159, v144, v145
    ds_write_b128 v217, v[156:159] offset:11264
    s_mul_i32 s34, s16, 12288
    s_add_u32 s34, s34, 98304
    v_add_u32 v1, s34, v223
    ds_write_b128 v1, v[160:163] offset:0
    ds_write_b128 v1, v[164:167] offset:1024
    ds_write_b128 v1, v[168:171] offset:2048
    v_and_b32 v2, 15, v216
    v_mul_u32_u24 v2, 192, v2
    v_lshrrev_b32 v3, 4, v216
    v_lshlrev_b32 v3, 4, v3
    v_add3_u32 v2, v2, v3, s34
    ds_read_b128 a[156:159], v2 offset:0
    ds_read_b128 a[160:163], v2 offset:64
    ds_read_b128 a[164:167], v2 offset:128
    s_mul_i32 s34, s16, 6144
    s_add_u32 s34, s34, 264192
    v_add_u32 v222, s34, v223
    s_lshl_b32 s34, s74, 15
    v_add_u32 v222, s34, v222
    s_waitcnt vmcnt(0)
GL_9:
    s_mov_b32 s37, 0
GI_10:
    global_load_dwordx4 v[224:227], v222, s[8:9] offset:-2048 sc1
    global_load_dwordx4 v[228:231], v222, s[8:9] offset:-1024 sc1
    global_load_dwordx4 v[232:235], v222, s[8:9] offset:0 sc1
    global_load_dwordx4 v[236:239], v222, s[8:9] offset:1024 sc1
    global_load_dwordx4 v[240:243], v222, s[8:9] offset:2048 sc1
    global_load_dwordx4 v[244:247], v222, s[8:9] offset:3072 sc1
    s_waitcnt vmcnt(0)
    v_xor_b32 v128, s50, v224
    v_xor_b32 v129, s50, v230
    v_xor_b32 v130, s50, v232
    v_xor_b32 v131, s50, v238
    v_xor_b32 v132, s50, v240
    v_xor_b32 v133, s50, v246
    v_or3_b32 v128, v128, v129, v130
    v_or3_b32 v131, v131, v132, v133
    v_or_b32 v128, v128, v131
    v_cmp_ne_u32 vcc, 0, v128
    s_cbranch_vccz GD_11
    s_add_u32 s37, s37, 1
    s_cmp_lt_u32 s37, 16
    s_cbranch_scc1 GI_10
    v_add_u32 v222, 65536, v222
    global_load_dwordx4 v[224:227], v222, s[8:9] offset:-2048 sc1
    global_load_dwordx4 v[228:231], v222, s[8:9] offset:-1024 sc1
    global_load_dwordx4 v[232:235], v222, s[8:9] offset:0 sc1
    global_load_dwordx4 v[236:239], v222, s[8:9] offset:1024 sc1
    global_load_dwordx4 v[240:243], v222, s[8:9] offset:2048 sc1
    global_load_dwordx4 v[244:247], v222, s[8:9] offset:3072 sc1
    v_subrev_u32 v222, 65536, v222
    s_waitcnt vmcnt(0)
    v_xor_b32 v128, s50, v224
    v_xor_b32 v129, s50, v230
    v_xor_b32 v130, s50, v232
    v_xor_b32 v131, s50, v238
    v_xor_b32 v132, s50, v240
    v_xor_b32 v133, s50, v246
    v_or3_b32 v128, v128, v129, v130
    v_or3_b32 v131, v131, v132, v133
    v_or_b32 v128, v128, v131
    v_cmp_ne_u32 vcc, 0, v128
    s_cbranch_vccz GD_11
    s_add_u32 s60, s60, 1
    s_cmp_lt_u32 s60, 65536
    s_cbranch_scc0 K_END
    s_branch GL_9
GD_11:
    s_mul_hi_u32 s34, s19, 89478486
    s_mul_i32 s35, s34, 48
    s_sub_u32 s35, s19, s35
    s_mul_i32 s34, s34, 589824
    s_mul_i32 s35, s35, 6144
    s_add_u32 s34, s34, s35
    s_add_u32 s44, s4, s34
    s_addc_u32 s45, s5, 0
    s_add_u32 s46, s44, 294912
    s_addc_u32 s47, s45, 0
    s_mul_i32 s34, s19, 3072
    s_add_u32 s48, s6, s34
    s_addc_u32 s49, s7, 0
    s_add_u32 s19, s19, 4
    global_load_dwordx4 v[116:119], v208, s[48:49] offset:0 nt
    global_load_dwordx4 v[68:71], v207, s[44:45] offset:0 nt
    global_load_dwordx4 v[72:75], v207, s[44:45] offset:768 nt
    global_load_dwordx4 v[76:79], v207, s[46:47] offset:0 nt
    global_load_dwordx4 v[80:83], v207, s[46:47] offset:768 nt
    global_load_dwordx4 v[120:123], v208, s[48:49] offset:256 nt
    global_load_dwordx4 v[84:87], v207, s[44:45] offset:256 nt
    global_load_dwordx4 v[88:91], v207, s[44:45] offset:1024 nt
    global_load_dwordx4 v[92:95], v207, s[46:47] offset:256 nt
    global_load_dwordx4 v[96:99], v207, s[46:47] offset:1024 nt
    s_waitcnt lgkmcnt(0)
    v_mfma_f32_16x16x32_bf16 v[184:187], a[156:159], v[226:229], 0
    v_mfma_f32_16x16x32_bf16 v[184:187], a[160:163], v[234:237], v[184:187]
    v_mfma_f32_16x16x32_bf16 v[184:187], a[164:167], v[242:245], v[184:187]
    s_nop 7
    s_cmp_eq_u32 s16, 0
    s_cbranch_scc1 XV0_14
    s_sub_u32 s34, s16, 1
    s_lshl_b32 s34, s34, 10
    s_add_u32 s34, s34, 104448
    v_add_u32 v1, s34, v223
    ds_write_b128 v1, v[184:187]
    s_waitcnt lgkmcnt(0)
XV0_14:
    s_barrier
    s_cmp_eq_u32 s16, 0
    s_cbranch_scc0 XV_13
    v_add_u32 v1, 104448, v223
    ds_read_b128 v[128:131], v1 offset:0
    ds_read_b128 v[132:135], v1 offset:1024
    ds_read_b128 v[136:139], v1 offset:2048
    s_waitcnt lgkmcnt(2)
    v_add_f32 v184, v184, v128
    v_add_f32 v185, v185, v129
    v_add_f32 v186, v186, v130
    v_add_f32 v187, v187, v131
    s_waitcnt lgkmcnt(1)
    v_add_f32 v184, v184, v132
    v_add_f32 v185, v185, v133
    v_add_f32 v186, v186, v134
    v_add_f32 v187, v187, v135
    s_waitcnt lgkmcnt(0)
    v_add_f32 v184, v184, v136
    v_add_f32 v185, v185, v137
    v_add_f32 v186, v186, v138
    v_add_f32 v187, v187, v139
    v_mul_f32 v184, 0x3d96c740, v184
    v_mul_f32 v185, 0x3d96c740, v185
    v_mul_f32 v186, 0x3d96c740, v186
    v_mul_f32 v187, 0x3d96c740, v187
    v_cvt_pk_bf16_f32 v130, v184, v185
    v_cvt_pk_bf16_f32 v131, v186, v187
    v_mov_b32 v128, s50
    v_mov_b32 v129, 0
    v_mov_b32 v132, s50
    v_mov_b32 v133, 0
    s_lshl_b32 s34, s53, 10
    s_add_u32 s34, s34, 32768
    v_add_u32 v1, s34, v223
    s_bitcmp1_b32 s53, 0
    s_cbranch_scc1 PB_O_15
    global_store_dwordx4 v1, v[128:131], s[8:9] sc1
    s_branch PB_G_16
PB_O_15:
    global_store_dwordx4 v1, v[130:133], s[8:9] sc1
PB_G_16:
XV_13:
    s_branch A0J_6
H2_5:
    v_add_u32 v217, 0, v209
    s_waitcnt vmcnt(5)
    v_lshlrev_b32 v136, 16, v56
    v_and_b32 v137, 0xffff0000, v56
    v_dot2_f32_bf16 v128, v8, s20, v136
    v_dot2_f32_bf16 v129, v12, s20, v136
    v_dot2_f32_bf16 v130, v16, s20, v136
    v_dot2_f32_bf16 v131, v20, s20, v136
    global_load_dwordx4 v[64:67], v208, s[14:15] offset:512 nt
    v_dot2_f32_bf16 v132, v8, s21, v137
    v_dot2_f32_bf16 v133, v12, s21, v137
    v_dot2_f32_bf16 v134, v16, s21, v137
    v_dot2_f32_bf16 v135, v20, s21, v137
    v_lshlrev_b32 v146, 16, v57
    v_and_b32 v147, 0xffff0000, v57
    v_dot2_f32_bf16 v138, v9, s20, v146
    v_cvt_pk_bf16_f32 v152, v128, v129
    v_dot2_f32_bf16 v139, v13, s20, v146
    v_cvt_pk_bf16_f32 v153, v130, v131
    v_dot2_f32_bf16 v140, v17, s20, v146
    v_cvt_pk_bf16_f32 v154, v132, v133
    v_dot2_f32_bf16 v141, v21, s20, v146
    v_cvt_pk_bf16_f32 v155, v134, v135
    ds_write_b128 v217, v[152:155] offset:0
    global_load_dwordx4 v[40:43], v207, s[10:11] offset:512 nt
    v_dot2_f32_bf16 v142, v9, s21, v147
    v_dot2_f32_bf16 v143, v13, s21, v147
    v_dot2_f32_bf16 v144, v17, s21, v147
    v_dot2_f32_bf16 v145, v21, s21, v147
    v_lshlrev_b32 v136, 16, v58
    v_and_b32 v137, 0xffff0000, v58
    global_load_dwordx4 v[44:47], v207, s[10:11] offset:1280 nt
    v_dot2_f32_bf16 v128, v10, s20, v136
    v_cvt_pk_bf16_f32 v156, v138, v139
    v_dot2_f32_bf16 v129, v14, s20, v136
    v_cvt_pk_bf16_f32 v157, v140, v141
    v_dot2_f32_bf16 v130, v18, s20, v136
    v_cvt_pk_bf16_f32 v158, v142, v143
    v_dot2_f32_bf16 v131, v22, s20, v136
    v_cvt_pk_bf16_f32 v159, v144, v145
    ds_write_b128 v217, v[156:159] offset:1024
    global_load_dwordx4 v[48:51], v207, s[12:13] offset:512 nt
    v_dot2_f32_bf16 v132, v10, s21, v137
    v_dot2_f32_bf16 v133, v14, s21, v137
    v_dot2_f32_bf16 v134, v18, s21, v137
    v_dot2_f32_bf16 v135, v22, s21, v137
    v_lshlrev_b32 v146, 16, v59
    v_and_b32 v147, 0xffff0000, v59
    v_dot2_f32_bf16 v138, v11, s20, v146
    v_cvt_pk_bf16_f32 v152, v128, v129
    v_dot2_f32_bf16 v139, v15, s20, v146
    v_cvt_pk_bf16_f32 v153, v130, v131
    v_dot2_f32_bf16 v140, v19, s20, v146
    v_cvt_pk_bf16_f32 v154, v132, v133
    v_dot2_f32_bf16 v141, v23, s20, v146
    v_cvt_pk_bf16_f32 v155, v134, v135
    ds_write_b128 v217, v[152:155] offset:2048
    global_load_dwordx4 v[52:55], v207, s[12:13] offset:1280 nt
    v_dot2_f32_bf16 v142, v11, s21, v147
    v_dot2_f32_bf16 v143, v15, s21, v147
    v_dot2_f32_bf16 v144, v19, s21, v147
    v_dot2_f32_bf16 v145, v23, s21, v147
    s_waitcnt vmcnt(5)
    v_lshlrev_b32 v136, 16, v60
    v_and_b32 v137, 0xffff0000, v60
    s_mul_hi_u32 s34, s19, 89478486
    s_mul_i32 s35, s34, 48
    s_sub_u32 s35, s19, s35
    s_mul_i32 s34, s34, 589824
    s_mul_i32 s35, s35, 6144
    s_add_u32 s34, s34, s35
    s_add_u32 s44, s4, s34
    s_addc_u32 s45, s5, 0
    s_add_u32 s46, s44, 294912
    s_addc_u32 s47, s45, 0
    s_mul_i32 s34, s19, 3072
    s_add_u32 s48, s6, s34
    s_addc_u32 s49, s7, 0
    s_add_u32 s19, s19, 4
    global_load_dwordx4 v[116:119], v208, s[48:49] offset:0 nt
    v_dot2_f32_bf16 v128, v24, s20, v136
    v_cvt_pk_bf16_f32 v156, v138, v139
    v_dot2_f32_bf16 v129, v28, s20, v136
    v_cvt_pk_bf16_f32 v157, v140, v141
    v_dot2_f32_bf16 v130, v32, s20, v136
    v_cvt_pk_bf16_f32 v158, v142, v143
    v_dot2_f32_bf16 v131, v36, s20, v136
    v_cvt_pk_bf16_f32 v159, v144, v145
    ds_write_b128 v217, v[156:159] offset:3072
    global_load_dwordx4 v[68:71], v207, s[44:45] offset:0 nt
    v_dot2_f32_bf16 v132, v24, s21, v137
    v_dot2_f32_bf16 v133, v28, s21, v137
    v_dot2_f32_bf16 v134, v32, s21, v137
    v_dot2_f32_bf16 v135, v36, s21, v137
    v_lshlrev_b32 v146, 16, v61
    v_and_b32 v147, 0xffff0000, v61
    v_dot2_f32_bf16 v138, v25, s20, v146
    v_cvt_pk_bf16_f32 v152, v128, v129
    v_dot2_f32_bf16 v139, v29, s20, v146
    v_cvt_pk_bf16_f32 v153, v130, v131
    v_dot2_f32_bf16 v140, v33, s20, v146
    v_cvt_pk_bf16_f32 v154, v132, v133
    v_dot2_f32_bf16 v141, v37, s20, v146
    v_cvt_pk_bf16_f32 v155, v134, v135
    ds_write_b128 v217, v[152:155] offset:4096
    global_load_dwordx4 v[72:75], v207, s[44:45] offset:768 nt
    v_dot2_f32_bf16 v142, v25, s21, v147
    v_dot2_f32_bf16 v143, v29, s21, v147
    v_dot2_f32_bf16 v144, v33, s21, v147
    v_dot2_f32_bf16 v145, v37, s21, v147
    v_lshlrev_b32 v136, 16, v62
    v_and_b32 v137, 0xffff0000, v62
    global_load_dwordx4 v[76:79], v207, s[46:47] offset:0 nt
    v_dot2_f32_bf16 v128, v26, s20, v136
    v_cvt_pk_bf16_f32 v156, v138, v139
    v_dot2_f32_bf16 v129, v30, s20, v136
    v_cvt_pk_bf16_f32 v157, v140, v141
    v_dot2_f32_bf16 v130, v34, s20, v136
    v_cvt_pk_bf16_f32 v158, v142, v143
    v_dot2_f32_bf16 v131, v38, s20, v136
    v_cvt_pk_bf16_f32 v159, v144, v145
    ds_write_b128 v217, v[156:159] offset:5120
    global_load_dwordx4 v[80:83], v207, s[46:47] offset:768 nt
    v_dot2_f32_bf16 v132, v26, s21, v137
    v_dot2_f32_bf16 v133, v30, s21, v137
    v_dot2_f32_bf16 v134, v34, s21, v137
    v_dot2_f32_bf16 v135, v38, s21, v137
    v_lshlrev_b32 v146, 16, v63
    v_and_b32 v147, 0xffff0000, v63
    v_dot2_f32_bf16 v138, v27, s20, v146
    v_cvt_pk_bf16_f32 v152, v128, v129
    v_dot2_f32_bf16 v139, v31, s20, v146
    v_cvt_pk_bf16_f32 v153, v130, v131
    v_dot2_f32_bf16 v140, v35, s20, v146
    v_cvt_pk_bf16_f32 v154, v132, v133
    v_dot2_f32_bf16 v141, v39, s20, v146
    v_cvt_pk_bf16_f32 v155, v134, v135
    ds_write_b128 v217, v[152:155] offset:6144
    v_dot2_f32_bf16 v142, v27, s21, v147
    v_dot2_f32_bf16 v143, v31, s21, v147
    v_dot2_f32_bf16 v144, v35, s21, v147
    v_dot2_f32_bf16 v145, v39, s21, v147
    s_waitcnt vmcnt(5)
    v_lshlrev_b32 v136, 16, v64
    v_and_b32 v137, 0xffff0000, v64
    global_load_dwordx4 v[120:123], v208, s[48:49] offset:256 nt
    v_dot2_f32_bf16 v128, v40, s20, v136
    v_cvt_pk_bf16_f32 v156, v138, v139
    v_dot2_f32_bf16 v129, v44, s20, v136
    v_cvt_pk_bf16_f32 v157, v140, v141
    v_dot2_f32_bf16 v130, v48, s20, v136
    v_cvt_pk_bf16_f32 v158, v142, v143
    v_dot2_f32_bf16 v131, v52, s20, v136
    v_cvt_pk_bf16_f32 v159, v144, v145
    ds_write_b128 v217, v[156:159] offset:7168
    global_load_dwordx4 v[84:87], v207, s[44:45] offset:256 nt
    v_dot2_f32_bf16 v132, v40, s21, v137
    v_dot2_f32_bf16 v133, v44, s21, v137
    v_dot2_f32_bf16 v134, v48, s21, v137
    v_dot2_f32_bf16 v135, v52, s21, v137
    v_lshlrev_b32 v146, 16, v65
    v_and_b32 v147, 0xffff0000, v65
    v_dot2_f32_bf16 v138, v41, s20, v146
    v_cvt_pk_bf16_f32 v152, v128, v129
    v_dot2_f32_bf16 v139, v45, s20, v146
    v_cvt_pk_bf16_f32 v153, v130, v131
    v_dot2_f32_bf16 v140, v49, s20, v146
    v_cvt_pk_bf16_f32 v154, v132, v133
    v_dot2_f32_bf16 v141, v53, s20, v146
    v_cvt_pk_bf16_f32 v155, v134, v135
    ds_write_b128 v217, v[152:155] offset:8192
    global_load_dwordx4 v[88:91], v207, s[44:45] offset:1024 nt
    v_dot2_f32_bf16 v142, v41, s21, v147
    v_dot2_f32_bf16 v143, v45, s21, v147
    v_dot2_f32_bf16 v144, v49, s21, v147
    v_dot2_f32_bf16 v145, v53, s21, v147
    v_lshlrev_b32 v136, 16, v66
    v_and_b32 v137, 0xffff0000, v66
    global_load_dwordx4 v[92:95], v207, s[46:47] offset:256 nt
    v_dot2_f32_bf16 v128, v42, s20, v136
    v_cvt_pk_bf16_f32 v156, v138, v139
    v_dot2_f32_bf16 v129, v46, s20, v136
    v_cvt_pk_bf16_f32 v157, v140, v141
    v_dot2_f32_bf16 v130, v50, s20, v136
    v_cvt_pk_bf16_f32 v158, v142, v143
    v_dot2_f32_bf16 v131, v54, s20, v136
    v_cvt_pk_bf16_f32 v159, v144, v145
    ds_write_b128 v217, v[156:159] offset:9216
    global_load_dwordx4 v[96:99], v207, s[46:47] offset:1024 nt
    v_dot2_f32_bf16 v132, v42, s21, v137
    v_dot2_f32_bf16 v133, v46, s21, v137
    v_dot2_f32_bf16 v134, v50, s21, v137
    v_dot2_f32_bf16 v135, v54, s21, v137
    v_lshlrev_b32 v146, 16, v67
    v_and_b32 v147, 0xffff0000, v67
    v_dot2_f32_bf16 v138, v43, s20, v146
    v_cvt_pk_bf16_f32 v152, v128, v129
    v_dot2_f32_bf16 v139, v47, s20, v146
    v_cvt_pk_bf16_f32 v153, v130, v131
    v_dot2_f32_bf16 v140, v51, s20, v146
    v_cvt_pk_bf16_f32 v154, v132, v133
    v_dot2_f32_bf16 v141, v55, s20, v146
    v_cvt_pk_bf16_f32 v155, v134, v135
    ds_write_b128 v217, v[152:155] offset:10240
    v_dot2_f32_bf16 v142, v43, s21, v147
    v_dot2_f32_bf16 v143, v47, s21, v147
    v_dot2_f32_bf16 v144, v51, s21, v147
    v_dot2_f32_bf16 v145, v55, s21, v147
    s_nop 0
    v_cvt_pk_bf16_f32 v156, v138, v139
    v_cvt_pk_bf16_f32 v157, v140, v141
    v_cvt_pk_bf16_f32 v158, v142, v143
    v_cvt_pk_bf16_f32 v159, v144, v145
    ds_write_b128 v217, v[156:159] offset:11264
A0J_6:
    v_and_b32 v1, 15, v216
    v_lshlrev_b32 v7, 4, v1
    v_lshrrev_b32 v4, 4, v216
    s_lshl_b32 s34, s17, 8
    s_add_u32 s34, s34, 131072
    v_lshlrev_b32 v6, 4, v1
    v_add_u32 v6, s34, v6
    s_mul_i32 s34, s16, 12288
    s_add_u32 s34, s34, 49152
    v_mul_u32_u24 v3, 272, v1
    v_lshlrev_b32 v5, 6, v4
    v_add3_u32 v3, v3, v5, s34
    v_lshlrev_b32 v5, 18, v4
    v_mul_u32_u24 v4, 272, v4
    v_add3_u32 v4, v4, v7, s34
    v_bfe_u32 v1, v216, 3, 1
    v_lshlrev_b32 v1, 15, v1
    v_and_b32 v2, 7, v216
    v_lshlrev_b32 v2, 4, v2
    v_add3_u32 v5, v5, v1, v2
    s_lshl_b32 s34, s16, 16
    s_lshl_b32 s35, s17, 7
    s_add_u32 s34, s34, s35
    s_add_u32 s34, s34, 1048576
    v_add_u32 v5, s34, v5
    v_add_u32 v7, 161856, v7
    s_lshl_b32 s34, s16, 2
    v_add_u32 v2, s34, v7
    s_add_u32 s76, s8, 1048576
    s_addc_u32 s77, s9, 0
    s_add_u32 s78, s8, 2097152
    s_addc_u32 s79, s9, 0
    s_add_u32 s80, s8, 3145728
    s_addc_u32 s81, s9, 0
    v_add_u32 v217, 49152, v209
    s_waitcnt vmcnt(5)
    v_lshlrev_b32 v136, 16, v116
    v_and_b32 v137, 0xffff0000, v116
    v_dot2_f32_bf16 v128, v68, s20, v136
    v_dot2_f32_bf16 v129, v72, s20, v136
    v_dot2_f32_bf16 v130, v76, s20, v136
    v_dot2_f32_bf16 v131, v80, s20, v136
    global_load_dwordx4 v[124:127], v208, s[48:49] offset:512 nt
    v_dot2_f32_bf16 v132, v68, s21, v137
    v_dot2_f32_bf16 v133, v72, s21, v137
    v_dot2_f32_bf16 v134, v76, s21, v137
    v_dot2_f32_bf16 v135, v80, s21, v137
    v_lshlrev_b32 v146, 16, v117
    v_and_b32 v147, 0xffff0000, v117
    v_dot2_f32_bf16 v138, v69, s20, v146
    v_cvt_pk_bf16_f32 v152, v128, v129
    v_dot2_f32_bf16 v139, v73, s20, v146
    v_cvt_pk_bf16_f32 v153, v130, v131
    v_dot2_f32_bf16 v140, v77, s20, v146
    v_cvt_pk_bf16_f32 v154, v132, v133
    v_dot2_f32_bf16 v141, v81, s20, v146
    v_cvt_pk_bf16_f32 v155, v134, v135
    ds_write_b128 v217, v[152:155] offset:0
    global_load_dwordx4 v[100:103], v207, s[44:45] offset:512 nt
    v_dot2_f32_bf16 v142, v69, s21, v147
    v_dot2_f32_bf16 v143, v73, s21, v147
    v_dot2_f32_bf16 v144, v77, s21, v147
    v_dot2_f32_bf16 v145, v81, s21, v147
    v_lshlrev_b32 v136, 16, v118
    v_and_b32 v137, 0xffff0000, v118
    global_load_dwordx4 v[104:107], v207, s[44:45] offset:1280 nt
    v_dot2_f32_bf16 v128, v70, s20, v136
    v_cvt_pk_bf16_f32 v156, v138, v139
    v_dot2_f32_bf16 v129, v74, s20, v136
    v_cvt_pk_bf16_f32 v157, v140, v141
    v_dot2_f32_bf16 v130, v78, s20, v136
    v_cvt_pk_bf16_f32 v158, v142, v143
    v_dot2_f32_bf16 v131, v82, s20, v136
    v_cvt_pk_bf16_f32 v159, v144, v145
    ds_write_b128 v217, v[156:159] offset:1024
    global_load_dwordx4 v[108:111], v207, s[46:47] offset:512 nt
    v_dot2_f32_bf16 v132, v70, s21, v137
    v_dot2_f32_bf16 v133, v74, s21, v137
    v_dot2_f32_bf16 v134, v78, s21, v137
    v_dot2_f32_bf16 v135, v82, s21, v137
    v_lshlrev_b32 v146, 16, v119
    v_and_b32 v147, 0xffff0000, v119
    v_dot2_f32_bf16 v138, v71, s20, v146
    v_cvt_pk_bf16_f32 v152, v128, v129
    v_dot2_f32_bf16 v139, v75, s20, v146
    v_cvt_pk_bf16_f32 v153, v130, v131
    v_dot2_f32_bf16 v140, v79, s20, v146
    v_cvt_pk_bf16_f32 v154, v132, v133
    v_dot2_f32_bf16 v141, v83, s20, v146
    v_cvt_pk_bf16_f32 v155, v134, v135
    ds_write_b128 v217, v[152:155] offset:2048
    global_load_dwordx4 v[112:115], v207, s[46:47] offset:1280 nt
    v_dot2_f32_bf16 v142, v71, s21, v147
    v_dot2_f32_bf16 v143, v75, s21, v147
    v_dot2_f32_bf16 v144, v79, s21, v147
    v_dot2_f32_bf16 v145, v83, s21, v147
    s_waitcnt vmcnt(5)
    v_lshlrev_b32 v136, 16, v120
    v_and_b32 v137, 0xffff0000, v120
    s_mul_hi_u32 s34, s19, 89478486
    s_mul_i32 s35, s34, 48
    s_sub_u32 s35, s19, s35
    s_mul_i32 s34, s34, 589824
    s_mul_i32 s35, s35, 6144
    s_add_u32 s34, s34, s35
    s_add_u32 s10, s4, s34
    s_addc_u32 s11, s5, 0
    s_add_u32 s12, s10, 294912
    s_addc_u32 s13, s11, 0
    s_mul_i32 s34, s19, 3072
    s_add_u32 s14, s6, s34
    s_addc_u32 s15, s7, 0
    s_add_u32 s19, s19, 4
    global_load_dwordx4 v[56:59], v208, s[14:15] offset:0 nt
    v_dot2_f32_bf16 v128, v84, s20, v136
    v_cvt_pk_bf16_f32 v156, v138, v139
    v_dot2_f32_bf16 v129, v88, s20, v136
    v_cvt_pk_bf16_f32 v157, v140, v141
    v_dot2_f32_bf16 v130, v92, s20, v136
    v_cvt_pk_bf16_f32 v158, v142, v143
    v_dot2_f32_bf16 v131, v96, s20, v136
    v_cvt_pk_bf16_f32 v159, v144, v145
    ds_write_b128 v217, v[156:159] offset:3072
    global_load_dwordx4 v[8:11], v207, s[10:11] offset:0 nt
    v_dot2_f32_bf16 v132, v84, s21, v137
    v_dot2_f32_bf16 v133, v88, s21, v137
    v_dot2_f32_bf16 v134, v92, s21, v137
    v_dot2_f32_bf16 v135, v96, s21, v137
    v_lshlrev_b32 v146, 16, v121
    v_and_b32 v147, 0xffff0000, v121
    v_dot2_f32_bf16 v138, v85, s20, v146
    v_cvt_pk_bf16_f32 v152, v128, v129
    v_dot2_f32_bf16 v139, v89, s20, v146
    v_cvt_pk_bf16_f32 v153, v130, v131
    v_dot2_f32_bf16 v140, v93, s20, v146
    v_cvt_pk_bf16_f32 v154, v132, v133
    v_dot2_f32_bf16 v141, v97, s20, v146
    v_cvt_pk_bf16_f32 v155, v134, v135
    ds_write_b128 v217, v[152:155] offset:4096
    global_load_dwordx4 v[12:15], v207, s[10:11] offset:768 nt
    v_dot2_f32_bf16 v142, v85, s21, v147
    v_dot2_f32_bf16 v143, v89, s21, v147
    v_dot2_f32_bf16 v144, v93, s21, v147
    v_dot2_f32_bf16 v145, v97, s21, v147
    v_lshlrev_b32 v136, 16, v122
    v_and_b32 v137, 0xffff0000, v122
    global_load_dwordx4 v[16:19], v207, s[12:13] offset:0 nt
    v_dot2_f32_bf16 v128, v86, s20, v136
    v_cvt_pk_bf16_f32 v156, v138, v139
    v_dot2_f32_bf16 v129, v90, s20, v136
    v_cvt_pk_bf16_f32 v157, v140, v141
    v_dot2_f32_bf16 v130, v94, s20, v136
    v_cvt_pk_bf16_f32 v158, v142, v143
    v_dot2_f32_bf16 v131, v98, s20, v136
    v_cvt_pk_bf16_f32 v159, v144, v145
    ds_write_b128 v217, v[156:159] offset:5120
    global_load_dwordx4 v[20:23], v207, s[12:13] offset:768 nt
    v_dot2_f32_bf16 v132, v86, s21, v137
    v_dot2_f32_bf16 v133, v90, s21, v137
    v_dot2_f32_bf16 v134, v94, s21, v137
    v_dot2_f32_bf16 v135, v98, s21, v137
    v_lshlrev_b32 v146, 16, v123
    v_and_b32 v147, 0xffff0000, v123
    v_dot2_f32_bf16 v138, v87, s20, v146
    v_cvt_pk_bf16_f32 v152, v128, v129
    v_dot2_f32_bf16 v139, v91, s20, v146
    v_cvt_pk_bf16_f32 v153, v130, v131
    v_dot2_f32_bf16 v140, v95, s20, v146
    v_cvt_pk_bf16_f32 v154, v132, v133
    v_dot2_f32_bf16 v141, v99, s20, v146
    v_cvt_pk_bf16_f32 v155, v134, v135
    ds_write_b128 v217, v[152:155] offset:6144
    v_dot2_f32_bf16 v142, v87, s21, v147
    v_dot2_f32_bf16 v143, v91, s21, v147
    v_dot2_f32_bf16 v144, v95, s21, v147
    v_dot2_f32_bf16 v145, v99, s21, v147
    s_waitcnt vmcnt(5)
    v_lshlrev_b32 v136, 16, v124
    v_and_b32 v137, 0xffff0000, v124
    global_load_dwordx4 v[60:63], v208, s[14:15] offset:256 nt
    v_dot2_f32_bf16 v128, v100, s20, v136
    v_cvt_pk_bf16_f32 v156, v138, v139
    v_dot2_f32_bf16 v129, v104, s20, v136
    v_cvt_pk_bf16_f32 v157, v140, v141
    v_dot2_f32_bf16 v130, v108, s20, v136
    v_cvt_pk_bf16_f32 v158, v142, v143
    v_dot2_f32_bf16 v131, v112, s20, v136
    v_cvt_pk_bf16_f32 v159, v144, v145
    ds_write_b128 v217, v[156:159] offset:7168
    global_load_dwordx4 v[24:27], v207, s[10:11] offset:256 nt
    v_dot2_f32_bf16 v132, v100, s21, v137
    v_dot2_f32_bf16 v133, v104, s21, v137
    v_dot2_f32_bf16 v134, v108, s21, v137
    v_dot2_f32_bf16 v135, v112, s21, v137
    v_lshlrev_b32 v146, 16, v125
    v_and_b32 v147, 0xffff0000, v125
    v_dot2_f32_bf16 v138, v101, s20, v146
    v_cvt_pk_bf16_f32 v152, v128, v129
    v_dot2_f32_bf16 v139, v105, s20, v146
    v_cvt_pk_bf16_f32 v153, v130, v131
    v_dot2_f32_bf16 v140, v109, s20, v146
    v_cvt_pk_bf16_f32 v154, v132, v133
    v_dot2_f32_bf16 v141, v113, s20, v146
    v_cvt_pk_bf16_f32 v155, v134, v135
    ds_write_b128 v217, v[152:155] offset:8192
    global_load_dwordx4 v[28:31], v207, s[10:11] offset:1024 nt
    v_dot2_f32_bf16 v142, v101, s21, v147
    v_dot2_f32_bf16 v143, v105, s21, v147
    v_dot2_f32_bf16 v144, v109, s21, v147
    v_dot2_f32_bf16 v145, v113, s21, v147
    v_lshlrev_b32 v136, 16, v126
    v_and_b32 v137, 0xffff0000, v126
    global_load_dwordx4 v[32:35], v207, s[12:13] offset:256 nt
    v_dot2_f32_bf16 v128, v102, s20, v136
    v_cvt_pk_bf16_f32 v156, v138, v139
    v_dot2_f32_bf16 v129, v106, s20, v136
    v_cvt_pk_bf16_f32 v157, v140, v141
    v_dot2_f32_bf16 v130, v110, s20, v136
    v_cvt_pk_bf16_f32 v158, v142, v143
    v_dot2_f32_bf16 v131, v114, s20, v136
    v_cvt_pk_bf16_f32 v159, v144, v145
    ds_write_b128 v217, v[156:159] offset:9216
    global_load_dwordx4 v[36:39], v207, s[12:13] offset:1024 nt
    v_dot2_f32_bf16 v132, v102, s21, v137
    v_dot2_f32_bf16 v133, v106, s21, v137
    v_dot2_f32_bf16 v134, v110, s21, v137
    v_dot2_f32_bf16 v135, v114, s21, v137
    v_lshlrev_b32 v146, 16, v127
    v_and_b32 v147, 0xffff0000, v127
    v_dot2_f32_bf16 v138, v103, s20, v146
    v_cvt_pk_bf16_f32 v152, v128, v129
    v_dot2_f32_bf16 v139, v107, s20, v146
    v_cvt_pk_bf16_f32 v153, v130, v131
    v_dot2_f32_bf16 v140, v111, s20, v146
    v_cvt_pk_bf16_f32 v154, v132, v133
    v_dot2_f32_bf16 v141, v115, s20, v146
    v_cvt_pk_bf16_f32 v155, v134, v135
    ds_write_b128 v217, v[152:155] offset:10240
    v_dot2_f32_bf16 v142, v103, s21, v147
    v_dot2_f32_bf16 v143, v107, s21, v147
    v_dot2_f32_bf16 v144, v111, s21, v147
    v_dot2_f32_bf16 v145, v115, s21, v147
    s_nop 0
    v_cvt_pk_bf16_f32 v156, v138, v139
    v_cvt_pk_bf16_f32 v157, v140, v141
    v_cvt_pk_bf16_f32 v158, v142, v143
    v_cvt_pk_bf16_f32 v159, v144, v145
    ds_write_b128 v217, v[156:159] offset:11264
    s_mul_i32 s34, s16, 6144
    s_add_u32 s34, s34, 34816
    v_add_u32 v222, s34, v223
    v_add_u32 v217, 98304, v209
    s_waitcnt vmcnt(5)
    v_lshlrev_b32 v136, 16, v56
    v_and_b32 v137, 0xffff0000, v56
    v_dot2_f32_bf16 v128, v8, s20, v136
    v_dot2_f32_bf16 v129, v12, s20, v136
    v_dot2_f32_bf16 v130, v16, s20, v136
    v_dot2_f32_bf16 v131, v20, s20, v136
    global_load_dwordx4 v[64:67], v208, s[14:15] offset:512 nt
    v_dot2_f32_bf16 v132, v8, s21, v137
    v_dot2_f32_bf16 v133, v12, s21, v137
    v_dot2_f32_bf16 v134, v16, s21, v137
    v_dot2_f32_bf16 v135, v20, s21, v137
    v_lshlrev_b32 v146, 16, v57
    v_and_b32 v147, 0xffff0000, v57
    v_dot2_f32_bf16 v138, v9, s20, v146
    v_cvt_pk_bf16_f32 v152, v128, v129
    v_dot2_f32_bf16 v139, v13, s20, v146
    v_cvt_pk_bf16_f32 v153, v130, v131
    v_dot2_f32_bf16 v140, v17, s20, v146
    v_cvt_pk_bf16_f32 v154, v132, v133
    v_dot2_f32_bf16 v141, v21, s20, v146
    v_cvt_pk_bf16_f32 v155, v134, v135
    ds_write_b128 v217, v[152:155] offset:0
    global_load_dwordx4 v[40:43], v207, s[10:11] offset:512 nt
    v_dot2_f32_bf16 v142, v9, s21, v147
    v_dot2_f32_bf16 v143, v13, s21, v147
    v_dot2_f32_bf16 v144, v17, s21, v147
    v_dot2_f32_bf16 v145, v21, s21, v147
    v_lshlrev_b32 v136, 16, v58
    v_and_b32 v137, 0xffff0000, v58
    v_dot2_f32_bf16 v128, v10, s20, v136
    v_cvt_pk_bf16_f32 v156, v138, v139
    v_dot2_f32_bf16 v129, v14, s20, v136
    v_cvt_pk_bf16_f32 v157, v140, v141
    v_dot2_f32_bf16 v130, v18, s20, v136
    v_cvt_pk_bf16_f32 v158, v142, v143
    v_dot2_f32_bf16 v131, v22, s20, v136
    v_cvt_pk_bf16_f32 v159, v144, v145
    ds_write_b128 v217, v[156:159] offset:1024
    global_load_dwordx4 v[44:47], v207, s[10:11] offset:1280 nt
    v_dot2_f32_bf16 v132, v10, s21, v137
    v_dot2_f32_bf16 v133, v14, s21, v137
    v_dot2_f32_bf16 v134, v18, s21, v137
    v_dot2_f32_bf16 v135, v22, s21, v137
    v_lshlrev_b32 v146, 16, v59
    v_and_b32 v147, 0xffff0000, v59
    v_dot2_f32_bf16 v138, v11, s20, v146
    v_cvt_pk_bf16_f32 v152, v128, v129
    v_dot2_f32_bf16 v139, v15, s20, v146
    v_cvt_pk_bf16_f32 v153, v130, v131
    v_dot2_f32_bf16 v140, v19, s20, v146
    v_cvt_pk_bf16_f32 v154, v132, v133
    v_dot2_f32_bf16 v141, v23, s20, v146
    v_cvt_pk_bf16_f32 v155, v134, v135
    ds_write_b128 v217, v[152:155] offset:2048
    global_load_dwordx4 v[48:51], v207, s[12:13] offset:512 nt
    v_dot2_f32_bf16 v142, v11, s21, v147
    v_dot2_f32_bf16 v143, v15, s21, v147
    v_dot2_f32_bf16 v144, v19, s21, v147
    v_dot2_f32_bf16 v145, v23, s21, v147
    s_waitcnt vmcnt(4)
    v_lshlrev_b32 v136, 16, v60
    v_and_b32 v137, 0xffff0000, v60
    v_dot2_f32_bf16 v128, v24, s20, v136
    v_cvt_pk_bf16_f32 v156, v138, v139
    v_dot2_f32_bf16 v129, v28, s20, v136
    v_cvt_pk_bf16_f32 v157, v140, v141
    v_dot2_f32_bf16 v130, v32, s20, v136
    v_cvt_pk_bf16_f32 v158, v142, v143
    v_dot2_f32_bf16 v131, v36, s20, v136
    v_cvt_pk_bf16_f32 v159, v144, v145
    ds_write_b128 v217, v[156:159] offset:3072
    global_load_dwordx4 v[52:55], v207, s[12:13] offset:1280 nt
    v_dot2_f32_bf16 v132, v24, s21, v137
    v_dot2_f32_bf16 v133, v28, s21, v137
    v_dot2_f32_bf16 v134, v32, s21, v137
    v_dot2_f32_bf16 v135, v36, s21, v137
    v_lshlrev_b32 v146, 16, v61
    v_and_b32 v147, 0xffff0000, v61
    v_dot2_f32_bf16 v138, v25, s20, v146
    v_cvt_pk_bf16_f32 v152, v128, v129
    v_dot2_f32_bf16 v139, v29, s20, v146
    v_cvt_pk_bf16_f32 v153, v130, v131
    v_dot2_f32_bf16 v140, v33, s20, v146
    v_cvt_pk_bf16_f32 v154, v132, v133
    v_dot2_f32_bf16 v141, v37, s20, v146
    v_cvt_pk_bf16_f32 v155, v134, v135
    ds_write_b128 v217, v[152:155] offset:4096
    v_dot2_f32_bf16 v142, v25, s21, v147
    v_dot2_f32_bf16 v143, v29, s21, v147
    v_dot2_f32_bf16 v144, v33, s21, v147
    v_dot2_f32_bf16 v145, v37, s21, v147
    v_lshlrev_b32 v136, 16, v62
    v_and_b32 v137, 0xffff0000, v62
    v_dot2_f32_bf16 v128, v26, s20, v136
    v_cvt_pk_bf16_f32 v156, v138, v139
    v_dot2_f32_bf16 v129, v30, s20, v136
    v_cvt_pk_bf16_f32 v157, v140, v141
    v_dot2_f32_bf16 v130, v34, s20, v136
    v_cvt_pk_bf16_f32 v158, v142, v143
    v_dot2_f32_bf16 v131, v38, s20, v136
    v_cvt_pk_bf16_f32 v159, v144, v145
    ds_write_b128 v217, v[156:159] offset:5120
    v_dot2_f32_bf16 v132, v26, s21, v137
    v_dot2_f32_bf16 v133, v30, s21, v137
    v_dot2_f32_bf16 v134, v34, s21, v137
    v_dot2_f32_bf16 v135, v38, s21, v137
    v_lshlrev_b32 v146, 16, v63
    v_and_b32 v147, 0xffff0000, v63
    v_dot2_f32_bf16 v138, v27, s20, v146
    v_cvt_pk_bf16_f32 v152, v128, v129
    v_dot2_f32_bf16 v139, v31, s20, v146
    v_cvt_pk_bf16_f32 v153, v130, v131
    v_dot2_f32_bf16 v140, v35, s20, v146
    v_cvt_pk_bf16_f32 v154, v132, v133
    v_dot2_f32_bf16 v141, v39, s20, v146
    v_cvt_pk_bf16_f32 v155, v134, v135
    ds_write_b128 v217, v[152:155] offset:6144
    v_dot2_f32_bf16 v142, v27, s21, v147
    v_dot2_f32_bf16 v143, v31, s21, v147
    v_dot2_f32_bf16 v144, v35, s21, v147
    v_dot2_f32_bf16 v145, v39, s21, v147
    s_waitcnt vmcnt(0)
    v_lshlrev_b32 v136, 16, v64
    v_and_b32 v137, 0xffff0000, v64
    v_dot2_f32_bf16 v128, v40, s20, v136
    v_cvt_pk_bf16_f32 v156, v138, v139
    v_dot2_f32_bf16 v129, v44, s20, v136
    v_cvt_pk_bf16_f32 v157, v140, v141
    v_dot2_f32_bf16 v130, v48, s20, v136
    v_cvt_pk_bf16_f32 v158, v142, v143
    v_dot2_f32_bf16 v131, v52, s20, v136
    v_cvt_pk_bf16_f32 v159, v144, v145
    ds_write_b128 v217, v[156:159] offset:7168
    v_dot2_f32_bf16 v132, v40, s21, v137
    v_dot2_f32_bf16 v133, v44, s21, v137
    v_dot2_f32_bf16 v134, v48, s21, v137
    v_dot2_f32_bf16 v135, v52, s21, v137
    v_lshlrev_b32 v146, 16, v65
    v_and_b32 v147, 0xffff0000, v65
    v_dot2_f32_bf16 v138, v41, s20, v146
    v_cvt_pk_bf16_f32 v152, v128, v129
    v_dot2_f32_bf16 v139, v45, s20, v146
    v_cvt_pk_bf16_f32 v153, v130, v131
    v_dot2_f32_bf16 v140, v49, s20, v146
    v_cvt_pk_bf16_f32 v154, v132, v133
    v_dot2_f32_bf16 v141, v53, s20, v146
    v_cvt_pk_bf16_f32 v155, v134, v135
    ds_write_b128 v217, v[152:155] offset:8192
    v_dot2_f32_bf16 v142, v41, s21, v147
    v_dot2_f32_bf16 v143, v45, s21, v147
    v_dot2_f32_bf16 v144, v49, s21, v147
    v_dot2_f32_bf16 v145, v53, s21, v147
    v_lshlrev_b32 v136, 16, v66
    v_and_b32 v137, 0xffff0000, v66
    v_dot2_f32_bf16 v128, v42, s20, v136
    v_cvt_pk_bf16_f32 v156, v138, v139
    v_dot2_f32_bf16 v129, v46, s20, v136
    v_cvt_pk_bf16_f32 v157, v140, v141
    v_dot2_f32_bf16 v130, v50, s20, v136
    v_cvt_pk_bf16_f32 v158, v142, v143
    v_dot2_f32_bf16 v131, v54, s20, v136
    v_cvt_pk_bf16_f32 v159, v144, v145
    ds_write_b128 v217, v[156:159] offset:9216
    v_dot2_f32_bf16 v132, v42, s21, v137
    v_dot2_f32_bf16 v133, v46, s21, v137
    v_dot2_f32_bf16 v134, v50, s21, v137
    v_dot2_f32_bf16 v135, v54, s21, v137
    v_lshlrev_b32 v146, 16, v67
    v_and_b32 v147, 0xffff0000, v67
    v_dot2_f32_bf16 v138, v43, s20, v146
    v_cvt_pk_bf16_f32 v152, v128, v129
    v_dot2_f32_bf16 v139, v47, s20, v146
    v_cvt_pk_bf16_f32 v153, v130, v131
    v_dot2_f32_bf16 v140, v51, s20, v146
    v_cvt_pk_bf16_f32 v154, v132, v133
    v_dot2_f32_bf16 v141, v55, s20, v146
    v_cvt_pk_bf16_f32 v155, v134, v135
    ds_write_b128 v217, v[152:155] offset:10240
    v_dot2_f32_bf16 v142, v43, s21, v147
    v_dot2_f32_bf16 v143, v47, s21, v147
    v_dot2_f32_bf16 v144, v51, s21, v147
    v_dot2_f32_bf16 v145, v55, s21, v147
    global_load_dwordx4 v[224:227], v222, s[8:9] offset:-2048 sc1
    global_load_dwordx4 v[228:231], v222, s[8:9] offset:-1024 sc1
    global_load_dwordx4 v[232:235], v222, s[8:9] offset:0 sc1
    global_load_dwordx4 v[236:239], v222, s[8:9] offset:1024 sc1
    global_load_dwordx4 v[240:243], v222, s[8:9] offset:2048 sc1
    global_load_dwordx4 v[244:247], v222, s[8:9] offset:3072 sc1
    s_mul_hi_u32 s34, s19, 89478486
    s_mul_i32 s35, s34, 48
    s_sub_u32 s35, s19, s35
    s_mul_i32 s34, s34, 589824
    s_mul_i32 s35, s35, 6144
    s_add_u32 s34, s34, s35
    s_add_u32 s44, s4, s34
    s_addc_u32 s45, s5, 0
    s_add_u32 s46, s44, 294912
    s_addc_u32 s47, s45, 0
    s_mul_i32 s34, s19, 3072
    s_add_u32 s48, s6, s34
    s_addc_u32 s49, s7, 0
    s_add_u32 s19, s19, 4
    global_load_dwordx4 v[116:119], v208, s[48:49] offset:0 nt
    global_load_dwordx4 v[68:71], v207, s[44:45] offset:0 nt
    global_load_dwordx4 v[72:75], v207, s[44:45] offset:768 nt
    global_load_dwordx4 v[76:79], v207, s[46:47] offset:0 nt
    global_load_dwordx4 v[80:83], v207, s[46:47] offset:768 nt
    global_load_dwordx4 v[120:123], v208, s[48:49] offset:256 nt
    global_load_dwordx4 v[84:87], v207, s[44:45] offset:256 nt
    global_load_dwordx4 v[88:91], v207, s[44:45] offset:1024 nt
    global_load_dwordx4 v[92:95], v207, s[46:47] offset:256 nt
    global_load_dwordx4 v[96:99], v207, s[46:47] offset:1024 nt
    s_nop 0
    v_cvt_pk_bf16_f32 v156, v138, v139
    v_cvt_pk_bf16_f32 v157, v140, v141
    v_cvt_pk_bf16_f32 v158, v142, v143
    v_cvt_pk_bf16_f32 v159, v144, v145
    ds_write_b128 v217, v[156:159] offset:11264
    global_load_dwordx4 v[124:127], v208, s[48:49] offset:512 nt
    global_load_dwordx4 v[100:103], v207, s[44:45] offset:512 nt
    global_load_dwordx4 v[104:107], v207, s[44:45] offset:1280 nt
    global_load_dwordx4 v[108:111], v207, s[46:47] offset:512 nt
    global_load_dwordx4 v[112:115], v207, s[46:47] offset:1280 nt
    s_nop 1
    v_mov_b32 v160, 0
    v_mov_b32 v161, 0
    v_mov_b32 v162, 0
    v_mov_b32 v163, 0
    v_mov_b32 v164, 0
    v_mov_b32 v165, 0
    v_mov_b32 v166, 0
    v_mov_b32 v167, 0
    v_mov_b32 v168, 0
    v_mov_b32 v169, 0
    v_mov_b32 v170, 0
    v_mov_b32 v171, 0
    v_mov_b32 v172, 0
    v_mov_b32 v173, 0
    v_mov_b32 v174, 0
    v_mov_b32 v175, 0
    v_mov_b32 v176, 0
    v_mov_b32 v177, 0
    v_mov_b32 v178, 0
    v_mov_b32 v179, 0
    v_mov_b32 v180, 0
    v_mov_b32 v181, 0
    v_mov_b32 v182, 0
    v_mov_b32 v183, 0
    s_waitcnt vmcnt(15)
    v_xor_b32 v128, s50, v224
    v_xor_b32 v129, s50, v230
    v_xor_b32 v130, s50, v232
    v_xor_b32 v131, s50, v238
    v_xor_b32 v132, s50, v240
    v_xor_b32 v133, s50, v246
    v_or3_b32 v128, v128, v129, v130
    v_or3_b32 v131, v131, v132, v133
    v_or_b32 v128, v128, v131
    v_cmp_ne_u32 vcc, 0, v128
    s_cbranch_vccz QK_OK_18
GL_20:
    global_load_dwordx4 v[224:227], v222, s[8:9] offset:-2048 sc1
    global_load_dwordx4 v[228:231], v222, s[8:9] offset:-1024 sc1
    global_load_dwordx4 v[232:235], v222, s[8:9] offset:0 sc1
    global_load_dwordx4 v[236:239], v222, s[8:9] offset:1024 sc1
    global_load_dwordx4 v[240:243], v222, s[8:9] offset:2048 sc1
    global_load_dwordx4 v[244:247], v222, s[8:9] offset:3072 sc1
    s_waitcnt vmcnt(0)
    v_xor_b32 v128, s50, v224
    v_xor_b32 v129, s50, v230
    v_xor_b32 v130, s50, v232
    v_xor_b32 v131, s50, v238
    v_xor_b32 v132, s50, v240
    v_xor_b32 v133, s50, v246
    v_or3_b32 v128, v128, v129, v130
    v_or3_b32 v131, v131, v132, v133
    v_or_b32 v128, v128, v131
    v_cmp_ne_u32 vcc, 0, v128
    s_cbranch_vccz GD_21
    s_add_u32 s60, s60, 1
    s_cmp_lt_u32 s60, 65536
    s_cbranch_scc0 K_END
    s_branch GL_20
GD_21:
QK_OK_18:
    s_mul_i32 s34, s16, 3072
    s_add_u32 s34, s34, 147456
    v_add_u32 v1, s34, v223
    ds_write_b128 v1, v[226:229] offset:0
    ds_write_b128 v1, v[234:237] offset:1024
    ds_write_b128 v1, v[242:245] offset:2048
    v_add_u32 v1, 147456, v223
    s_waitcnt lgkmcnt(0)
    s_barrier
    ds_read_b128 a[0:3], v1 offset:0
    ds_read_b128 a[4:7], v1 offset:1024
    ds_read_b128 a[8:11], v1 offset:2048
    ds_read_b128 a[12:15], v1 offset:3072
    ds_read_b128 a[16:19], v1 offset:4096
    ds_read_b128 a[20:23], v1 offset:5120
    ds_read_b128 a[24:27], v1 offset:6144
    ds_read_b128 a[28:31], v1 offset:7168
    ds_read_b128 a[32:35], v1 offset:8192
    ds_read_b128 a[36:39], v1 offset:9216
    ds_read_b128 a[40:43], v1 offset:10240
    ds_read_b128 a[44:47], v1 offset:11264
    s_waitcnt lgkmcnt(8)
    v_mfma_f32_16x16x32_bf16 v[184:187], a[152:155], a[0:3], 0
    v_mfma_f32_16x16x32_bf16 v[184:187], a[152:155], a[4:7], v[184:187]
    v_mfma_f32_16x16x32_bf16 v[184:187], a[152:155], a[8:11], v[184:187]
    v_mfma_f32_16x16x32_bf16 v[184:187], a[152:155], a[12:15], v[184:187]
    s_waitcnt lgkmcnt(4)
    v_mfma_f32_16x16x32_bf16 v[184:187], a[152:155], a[16:19], v[184:187]
    v_mfma_f32_16x16x32_bf16 v[184:187], a[152:155], a[20:23], v[184:187]
    v_mfma_f32_16x16x32_bf16 v[184:187], a[152:155], a[24:27], v[184:187]
    v_mfma_f32_16x16x32_bf16 v[184:187], a[152:155], a[28:31], v[184:187]
    s_waitcnt lgkmcnt(0)
    v_mfma_f32_16x16x32_bf16 v[184:187], a[152:155], a[32:35], v[184:187]
    v_mfma_f32_16x16x32_bf16 v[184:187], a[152:155], a[36:39], v[184:187]
    v_mfma_f32_16x16x32_bf16 v[184:187], a[152:155], a[40:43], v[184:187]
    v_mfma_f32_16x16x32_bf16 v[184:187], a[152:155], a[44:47], v[184:187]
    s_nop 7
    v_mov_b32 v204, v184
    v_add_u32 v218, 0, v210
    v_add_u32 v219, 0, v211
    v_add_u32 v220, 0, v212
    ds_read_b64_tr_b16 a[48:49], v218 offset:0
    ds_read_b64_tr_b16 a[50:51], v219 offset:0
    ds_read_b64_tr_b16 a[52:53], v218 offset:1024
    ds_read_b64_tr_b16 a[54:55], v219 offset:1024
    ds_read_b64_tr_b16 a[56:57], v218 offset:2048
    ds_read_b64_tr_b16 a[58:59], v219 offset:2048
    ds_read_b64_tr_b16 a[60:61], v218 offset:3072
    ds_read_b64_tr_b16 a[62:63], v219 offset:3072
    ds_read_b64_tr_b16 a[64:65], v218 offset:4096
    ds_read_b64_tr_b16 a[66:67], v219 offset:4096
    ds_read_b64_tr_b16 a[68:69], v218 offset:5120
    ds_read_b64_tr_b16 a[70:71], v219 offset:5120
    ds_read_b64_tr_b16 a[72:73], v218 offset:6144
    ds_read_b64_tr_b16 a[74:75], v219 offset:6144
    ds_read_b64_tr_b16 a[76:77], v218 offset:7168
    ds_read_b64_tr_b16 a[78:79], v219 offset:7168
    ds_read_b64_tr_b16 a[80:81], v218 offset:8192
    ds_read_b64_tr_b16 a[82:83], v219 offset:8192
    ds_read_b64_tr_b16 a[84:85], v218 offset:9216
    ds_read_b64_tr_b16 a[86:87], v219 offset:9216
    ds_read_b64_tr_b16 a[88:89], v218 offset:10240
    ds_read_b64_tr_b16 a[90:91], v219 offset:10240
    ds_read_b64_tr_b16 a[92:93], v218 offset:11264
    ds_read_b64_tr_b16 a[94:95], v219 offset:11264
    s_waitcnt lgkmcnt(15)
    v_mfma_f32_16x16x32_bf16 v[192:195], a[48:51], a[48:51], 0
    ds_read_b128 a[96:99], v220 offset:0
    v_mfma_f32_16x16x32_bf16 v[192:195], a[52:55], a[52:55], v[192:195]
    ds_read_b128 a[100:103], v220 offset:4096
    s_mul_hi_u32 s34, s19, 89478486
    s_mul_i32 s35, s34, 48
    s_sub_u32 s35, s19, s35
    s_mul_i32 s34, s34, 589824
    s_mul_i32 s35, s35, 6144
    s_add_u32 s34, s34, s35
    s_add_u32 s10, s4, s34
    s_addc_u32 s11, s5, 0
    s_add_u32 s12, s10, 294912
    s_addc_u32 s13, s11, 0
    s_mul_i32 s34, s19, 3072
    s_add_u32 s14, s6, s34
    s_addc_u32 s15, s7, 0
    s_add_u32 s19, s19, 4
    global_load_dwordx4 v[56:59], v208, s[14:15] offset:0 nt
    v_mfma_f32_16x16x32_bf16 v[192:195], a[56:59], a[56:59], v[192:195]
    ds_read_b128 a[104:107], v220 offset:8192
    s_waitcnt lgkmcnt(15)
    v_mfma_f32_16x16x32_bf16 v[192:195], a[60:63], a[60:63], v[192:195]
    ds_read_b128 a[108:111], v220 offset:12288
    global_load_dwordx4 v[8:11], v207, s[10:11] offset:0 nt
    v_mfma_f32_16x16x32_bf16 v[192:195], a[64:67], a[64:67], v[192:195]
    ds_read_b128 a[112:115], v220 offset:16384
    v_mfma_f32_16x16x32_bf16 v[192:195], a[68:71], a[68:71], v[192:195]
    ds_read_b128 a[116:119], v220 offset:20480
    global_load_dwordx4 v[12:15], v207, s[10:11] offset:768 nt
    s_waitcnt lgkmcnt(12)
    v_mfma_f32_16x16x32_bf16 v[192:195], a[72:75], a[72:75], v[192:195]
    ds_read_b128 a[120:123], v220 offset:24576
    v_mfma_f32_16x16x32_bf16 v[192:195], a[76:79], a[76:79], v[192:195]
    ds_read_b128 a[124:127], v220 offset:28672
    global_load_dwordx4 v[16:19], v207, s[12:13] offset:0 nt
    v_mfma_f32_16x16x32_bf16 v[192:195], a[80:83], a[80:83], v[192:195]
    ds_read_b128 a[128:131], v220 offset:32768
    s_waitcnt lgkmcnt(9)
    v_mfma_f32_16x16x32_bf16 v[192:195], a[84:87], a[84:87], v[192:195]
    ds_read_b128 a[132:135], v220 offset:36864
    global_load_dwordx4 v[20:23], v207, s[12:13] offset:768 nt
    v_mfma_f32_16x16x32_bf16 v[192:195], a[88:91], a[88:91], v[192:195]
    ds_read_b128 a[136:139], v220 offset:40960
    v_mfma_f32_16x16x32_bf16 v[192:195], a[92:95], a[92:95], v[192:195]
    ds_read_b128 a[140:143], v220 offset:45056
    v_mfma_f32_16x16x32_bf16 v[188:191], a[48:51], a[152:155], 0
    v_mfma_f32_16x16x32_bf16 v[188:191], a[52:55], a[152:155], v[188:191]
    v_mfma_f32_16x16x32_bf16 v[188:191], a[56:59], a[152:155], v[188:191]
    v_mfma_f32_16x16x32_bf16 v[188:191], a[60:63], a[152:155], v[188:191]
    v_mfma_f32_16x16x32_bf16 v[188:191], a[64:67], a[152:155], v[188:191]
    v_mfma_f32_16x16x32_bf16 v[188:191], a[68:71], a[152:155], v[188:191]
    v_mfma_f32_16x16x32_bf16 v[188:191], a[72:75], a[152:155], v[188:191]
    v_mfma_f32_16x16x32_bf16 v[188:191], a[76:79], a[152:155], v[188:191]
    v_cndmask_b32 v128, 0, v192, s[26:27]
    v_mfma_f32_16x16x32_bf16 v[188:191], a[80:83], a[152:155], v[188:191]
    v_cndmask_b32 v128, v128, v193, s[28:29]
    v_mfma_f32_16x16x32_bf16 v[188:191], a[84:87], a[152:155], v[188:191]
    v_cndmask_b32 v128, v128, v194, s[30:31]
    v_mfma_f32_16x16x32_bf16 v[188:191], a[88:91], a[152:155], v[188:191]
    v_cndmask_b32 v128, v128, v195, s[32:33]
    v_mfma_f32_16x16x32_bf16 v[188:191], a[92:95], a[152:155], v[188:191]
    v_mfma_f32_16x16x32_bf16 v[184:187], a[48:51], a[0:3], 0
    v_mfma_f32_16x16x4_f32 v[196:199], v128, v205, 0
    v_mfma_f32_16x16x32_bf16 v[184:187], a[52:55], a[4:7], v[184:187]
    v_mfma_f32_16x16x32_bf16 v[184:187], a[56:59], a[8:11], v[184:187]
    v_mfma_f32_16x16x32_bf16 v[184:187], a[60:63], a[12:15], v[184:187]
    v_mfma_f32_16x16x32_bf16 v[184:187], a[64:67], a[16:19], v[184:187]
    v_mfma_f32_16x16x32_bf16 v[184:187], a[68:71], a[20:23], v[184:187]
    v_mfma_f32_16x16x32_bf16 v[184:187], a[72:75], a[24:27], v[184:187]
    v_mul_f32 v188, s23, v188
    v_mfma_f32_16x16x32_bf16 v[184:187], a[76:79], a[28:31], v[184:187]
    v_mul_f32 v189, s23, v189
    v_mfma_f32_16x16x32_bf16 v[184:187], a[80:83], a[32:35], v[184:187]
    v_mul_f32 v190, s23, v190
    v_mfma_f32_16x16x32_bf16 v[184:187], a[84:87], a[36:39], v[184:187]
    v_mul_f32 v191, s23, v191
    v_mfma_f32_16x16x32_bf16 v[184:187], a[88:91], a[40:43], v[184:187]
    v_fma_f32 v128, -v188, v188, v206
    v_fma_f32 v129, -v189, v189, v206
    v_mfma_f32_16x16x32_bf16 v[184:187], a[92:95], a[44:47], v[184:187]
    v_fma_f32 v130, -v190, v190, v206
    v_fma_f32 v131, -v191, v191, v206
    v_fma_f32 v196, v196, s23, v128
    v_fma_f32 v197, v197, s23, v129
    v_fma_f32 v198, v198, s23, v130
    v_fma_f32 v199, v199, s23, v131
    v_rsq_f32 v196, v196
    v_rsq_f32 v197, v197
    v_rsq_f32 v198, v198
    v_rsq_f32 v199, v199
    v_pk_fma_f32 v[184:185], v[188:189], v[204:205], v[184:185] op_sel_hi:[1,0,1] neg_lo:[1,0,0] neg_hi:[1,0,0]
    v_pk_fma_f32 v[186:187], v[190:191], v[204:205], v[186:187] op_sel_hi:[1,0,1] neg_lo:[1,0,0] neg_hi:[1,0,0]
    v_pk_fma_f32 v[136:137], v[184:185], v[196:197], v[202:203] op_sel_hi:[1,1,0] neg_lo:[0,0,1] neg_hi:[0,0,1]
    v_pk_fma_f32 v[138:139], v[186:187], v[198:199], v[202:203] op_sel_hi:[1,1,0] neg_lo:[0,0,1] neg_hi:[0,0,1]
    v_max3_f32 v128, v136, v137, v138
    v_max_f32 v128, v128, v139
    v_cmp_lt_f32 vcc, s61, v128
    v_exp_f32 v136, v136
    v_exp_f32 v137, v137
    v_exp_f32 v138, v138
    v_exp_f32 v139, v139
    s_nop 0
    v_pk_mul_f32 v[132:133], v[136:137], v[196:197]
    v_pk_mul_f32 v[134:135], v[138:139], v[198:199]
    v_cvt_pk_bf16_f32 v200, v132, v133
    v_cvt_pk_bf16_f32 v201, v134, v135
    ds_write_b64 v213, v[200:201] offset:12288
    v_cndmask_b32 v128, 0, 1, vcc
    ds_write_b32 v254, v128 offset:10816
    v_add_f32 v136, v136, v137
    v_add_f32 v138, v138, v139
    v_lshlrev_b32 v132, 16, v200
    v_and_b32 v133, 0xffff0000, v200
    v_lshlrev_b32 v134, 16, v201
    v_and_b32 v135, 0xffff0000, v201
    v_add_f32 v140, v136, v138
    v_mul_f32 v141, v132, v188
    v_mul_f32 v132, v133, v189
    v_fmac_f32 v141, v134, v190
    v_fmac_f32 v132, v135, v191
    v_add_f32 v141, v141, v132
    s_waitcnt lgkmcnt(0)
    s_barrier
    ds_read_b128 v[128:131], v255 offset:10816
    ds_read_b64 a[144:145], v214 offset:12288
    ds_read_b64 a[146:147], v214 offset:12800
    ds_read_b64 a[148:149], v214 offset:13312
    ds_read_b64 a[150:151], v214 offset:13824
    s_waitcnt lgkmcnt(4)
    v_or3_b32 v128, v128, v129, v130
    v_or_b32 v128, v128, v131
    v_cmp_ne_u32 vcc, 0, v128
    s_cbranch_vccz BJ_23
    v_mul_f32 v136, v184, v196
    v_mul_f32 v137, v185, v197
    v_mul_f32 v138, v186, v198
    v_mul_f32 v139, v187, v199
    v_max3_f32 v128, v136, v137, v138
    v_max_f32 v128, v128, v139
    ds_max_f32 v215, v128
    s_waitcnt lgkmcnt(0)
    s_barrier
    ds_read_b32 v129, v215
    s_waitcnt lgkmcnt(0)
    v_sub_f32 v130, v202, v129
    v_sub_f32 v136, v136, v129
    v_sub_f32 v137, v137, v129
    v_sub_f32 v138, v138, v129
    v_sub_f32 v139, v139, v129
    v_exp_f32 v130, v130
    v_mov_b32 v202, v129
    v_exp_f32 v136, v136
    v_exp_f32 v137, v137
    v_exp_f32 v138, v138
    v_exp_f32 v139, v139
    s_nop 0
    v_pk_mul_f32 v[132:133], v[136:137], v[196:197]
    v_pk_mul_f32 v[134:135], v[138:139], v[198:199]
    v_cvt_pk_bf16_f32 v200, v132, v133
    v_cvt_pk_bf16_f32 v201, v134, v135
    ds_write_b64 v213, v[200:201] offset:12288
    v_mul_f32 v203, v203, v130
    v_mul_f32 v221, v221, v130
    v_pk_mul_f32 v[160:161], v[160:161], v[130:131] op_sel_hi:[1,0]
    v_pk_mul_f32 v[162:163], v[162:163], v[130:131] op_sel_hi:[1,0]
    v_pk_mul_f32 v[164:165], v[164:165], v[130:131] op_sel_hi:[1,0]
    v_pk_mul_f32 v[166:167], v[166:167], v[130:131] op_sel_hi:[1,0]
    v_pk_mul_f32 v[168:169], v[168:169], v[130:131] op_sel_hi:[1,0]
    v_pk_mul_f32 v[170:171], v[170:171], v[130:131] op_sel_hi:[1,0]
    v_pk_mul_f32 v[172:173], v[172:173], v[130:131] op_sel_hi:[1,0]
    v_pk_mul_f32 v[174:175], v[174:175], v[130:131] op_sel_hi:[1,0]
    v_pk_mul_f32 v[176:177], v[176:177], v[130:131] op_sel_hi:[1,0]
    v_pk_mul_f32 v[178:179], v[178:179], v[130:131] op_sel_hi:[1,0]
    v_pk_mul_f32 v[180:181], v[180:181], v[130:131] op_sel_hi:[1,0]
    v_pk_mul_f32 v[182:183], v[182:183], v[130:131] op_sel_hi:[1,0]
    v_add_f32 v136, v136, v137
    v_add_f32 v138, v138, v139
    v_lshlrev_b32 v132, 16, v200
    v_and_b32 v133, 0xffff0000, v200
    v_lshlrev_b32 v134, 16, v201
    v_and_b32 v135, 0xffff0000, v201
    v_add_f32 v140, v136, v138
    v_mul_f32 v141, v132, v188
    v_mul_f32 v132, v133, v189
    v_fmac_f32 v141, v134, v190
    v_fmac_f32 v132, v135, v191
    v_add_f32 v141, v141, v132
    s_waitcnt lgkmcnt(0)
    s_barrier
    ds_read_b64 a[144:145], v214 offset:12288
    ds_read_b64 a[146:147], v214 offset:12800
    ds_read_b64 a[148:149], v214 offset:13312
    ds_read_b64 a[150:151], v214 offset:13824
BJ_23:
    v_add_f32 v203, v203, v140
    v_add_f32 v221, v221, v141
    v_add_u32 v217, 0, v209
    s_waitcnt lgkmcnt(0)
    s_waitcnt vmcnt(15)
    v_lshlrev_b32 v136, 16, v116
    v_and_b32 v137, 0xffff0000, v116
    v_dot2_f32_bf16 v128, v68, s20, v136
    v_dot2_f32_bf16 v129, v72, s20, v136
    v_dot2_f32_bf16 v130, v76, s20, v136
    v_dot2_f32_bf16 v131, v80, s20, v136
    global_load_dwordx4 v[60:63], v208, s[14:15] offset:256 nt
    v_dot2_f32_bf16 v132, v68, s21, v137
    v_dot2_f32_bf16 v133, v72, s21, v137
    v_dot2_f32_bf16 v134, v76, s21, v137
    v_dot2_f32_bf16 v135, v80, s21, v137
    v_lshlrev_b32 v146, 16, v117
    v_and_b32 v147, 0xffff0000, v117
    v_dot2_f32_bf16 v138, v69, s20, v146
    v_cvt_pk_bf16_f32 v152, v128, v129
    v_dot2_f32_bf16 v139, v73, s20, v146
    v_cvt_pk_bf16_f32 v153, v130, v131
    v_dot2_f32_bf16 v140, v77, s20, v146
    v_cvt_pk_bf16_f32 v154, v132, v133
    v_dot2_f32_bf16 v141, v81, s20, v146
    v_cvt_pk_bf16_f32 v155, v134, v135
    v_mfma_f32_16x16x16_bf16 v[160:163], a[96:97], a[144:145], v[160:163]
    v_mfma_f32_16x16x16_bf16 v[164:167], a[98:99], a[144:145], v[164:167]
    ds_write_b128 v217, v[152:155] offset:0
    global_load_dwordx4 v[24:27], v207, s[10:11] offset:256 nt
    v_dot2_f32_bf16 v142, v69, s21, v147
    v_dot2_f32_bf16 v143, v73, s21, v147
    v_dot2_f32_bf16 v144, v77, s21, v147
    v_dot2_f32_bf16 v145, v81, s21, v147
    v_lshlrev_b32 v136, 16, v118
    v_and_b32 v137, 0xffff0000, v118
    v_dot2_f32_bf16 v128, v70, s20, v136
    v_cvt_pk_bf16_f32 v156, v138, v139
    v_dot2_f32_bf16 v129, v74, s20, v136
    v_cvt_pk_bf16_f32 v157, v140, v141
    v_dot2_f32_bf16 v130, v78, s20, v136
    v_cvt_pk_bf16_f32 v158, v142, v143
    v_dot2_f32_bf16 v131, v82, s20, v136
    v_cvt_pk_bf16_f32 v159, v144, v145
    v_mfma_f32_16x16x16_bf16 v[168:171], a[100:101], a[144:145], v[168:171]
    v_mfma_f32_16x16x16_bf16 v[172:175], a[102:103], a[144:145], v[172:175]
    ds_write_b128 v217, v[156:159] offset:1024
    global_load_dwordx4 v[28:31], v207, s[10:11] offset:1024 nt
    v_dot2_f32_bf16 v132, v70, s21, v137
    v_dot2_f32_bf16 v133, v74, s21, v137
    v_dot2_f32_bf16 v134, v78, s21, v137
    v_dot2_f32_bf16 v135, v82, s21, v137
    v_lshlrev_b32 v146, 16, v119
    v_and_b32 v147, 0xffff0000, v119
    v_dot2_f32_bf16 v138, v71, s20, v146
    v_cvt_pk_bf16_f32 v152, v128, v129
    v_dot2_f32_bf16 v139, v75, s20, v146
    v_cvt_pk_bf16_f32 v153, v130, v131
    v_dot2_f32_bf16 v140, v79, s20, v146
    v_cvt_pk_bf16_f32 v154, v132, v133
    v_dot2_f32_bf16 v141, v83, s20, v146
    v_cvt_pk_bf16_f32 v155, v134, v135
    v_mfma_f32_16x16x16_bf16 v[176:179], a[104:105], a[144:145], v[176:179]
    v_mfma_f32_16x16x16_bf16 v[180:183], a[106:107], a[144:145], v[180:183]
    ds_write_b128 v217, v[152:155] offset:2048
    global_load_dwordx4 v[32:35], v207, s[12:13] offset:256 nt
    v_dot2_f32_bf16 v142, v71, s21, v147
    v_dot2_f32_bf16 v143, v75, s21, v147
    v_dot2_f32_bf16 v144, v79, s21, v147
    v_dot2_f32_bf16 v145, v83, s21, v147
    s_waitcnt vmcnt(14)
    v_lshlrev_b32 v136, 16, v120
    v_and_b32 v137, 0xffff0000, v120
    v_dot2_f32_bf16 v128, v84, s20, v136
    v_cvt_pk_bf16_f32 v156, v138, v139
    v_dot2_f32_bf16 v129, v88, s20, v136
    v_cvt_pk_bf16_f32 v157, v140, v141
    v_dot2_f32_bf16 v130, v92, s20, v136
    v_cvt_pk_bf16_f32 v158, v142, v143
    v_dot2_f32_bf16 v131, v96, s20, v136
    v_cvt_pk_bf16_f32 v159, v144, v145
    v_mfma_f32_16x16x16_bf16 v[160:163], a[108:109], a[146:147], v[160:163]
    v_mfma_f32_16x16x16_bf16 v[164:167], a[110:111], a[146:147], v[164:167]
    ds_write_b128 v217, v[156:159] offset:3072
    global_load_dwordx4 v[36:39], v207, s[12:13] offset:1024 nt
    v_dot2_f32_bf16 v132, v84, s21, v137
    v_dot2_f32_bf16 v133, v88, s21, v137
    v_dot2_f32_bf16 v134, v92, s21, v137
    v_dot2_f32_bf16 v135, v96, s21, v137
    v_lshlrev_b32 v146, 16, v121
    v_and_b32 v147, 0xffff0000, v121
    v_dot2_f32_bf16 v138, v85, s20, v146
    v_cvt_pk_bf16_f32 v152, v128, v129
    v_dot2_f32_bf16 v139, v89, s20, v146
    v_cvt_pk_bf16_f32 v153, v130, v131
    v_dot2_f32_bf16 v140, v93, s20, v146
    v_cvt_pk_bf16_f32 v154, v132, v133
    v_dot2_f32_bf16 v141, v97, s20, v146
    v_cvt_pk_bf16_f32 v155, v134, v135
    v_mfma_f32_16x16x16_bf16 v[168:171], a[112:113], a[146:147], v[168:171]
    v_mfma_f32_16x16x16_bf16 v[172:175], a[114:115], a[146:147], v[172:175]
    ds_write_b128 v217, v[152:155] offset:4096
    v_dot2_f32_bf16 v142, v85, s21, v147
    v_dot2_f32_bf16 v143, v89, s21, v147
    v_dot2_f32_bf16 v144, v93, s21, v147
    v_dot2_f32_bf16 v145, v97, s21, v147
    v_lshlrev_b32 v136, 16, v122
    v_and_b32 v137, 0xffff0000, v122
    v_dot2_f32_bf16 v128, v86, s20, v136
    v_cvt_pk_bf16_f32 v156, v138, v139
    v_dot2_f32_bf16 v129, v90, s20, v136
    v_cvt_pk_bf16_f32 v157, v140, v141
    v_dot2_f32_bf16 v130, v94, s20, v136
    v_cvt_pk_bf16_f32 v158, v142, v143
    v_dot2_f32_bf16 v131, v98, s20, v136
    v_cvt_pk_bf16_f32 v159, v144, v145
    v_mfma_f32_16x16x16_bf16 v[176:179], a[116:117], a[146:147], v[176:179]
    v_mfma_f32_16x16x16_bf16 v[180:183], a[118:119], a[146:147], v[180:183]
    ds_write_b128 v217, v[156:159] offset:5120
    global_load_dwordx4 v[64:67], v208, s[14:15] offset:512 nt
    v_dot2_f32_bf16 v132, v86, s21, v137
    v_dot2_f32_bf16 v133, v90, s21, v137
    v_dot2_f32_bf16 v134, v94, s21, v137
    v_dot2_f32_bf16 v135, v98, s21, v137
    v_lshlrev_b32 v146, 16, v123
    v_and_b32 v147, 0xffff0000, v123
    v_dot2_f32_bf16 v138, v87, s20, v146
    v_cvt_pk_bf16_f32 v152, v128, v129
    v_dot2_f32_bf16 v139, v91, s20, v146
    v_cvt_pk_bf16_f32 v153, v130, v131
    v_dot2_f32_bf16 v140, v95, s20, v146
    v_cvt_pk_bf16_f32 v154, v132, v133
    v_dot2_f32_bf16 v141, v99, s20, v146
    v_cvt_pk_bf16_f32 v155, v134, v135
    v_mfma_f32_16x16x16_bf16 v[160:163], a[120:121], a[148:149], v[160:163]
    v_mfma_f32_16x16x16_bf16 v[164:167], a[122:123], a[148:149], v[164:167]
    ds_write_b128 v217, v[152:155] offset:6144
    global_load_dwordx4 v[40:43], v207, s[10:11] offset:512 nt
    v_dot2_f32_bf16 v142, v87, s21, v147
    v_dot2_f32_bf16 v143, v91, s21, v147
    v_dot2_f32_bf16 v144, v95, s21, v147
    v_dot2_f32_bf16 v145, v99, s21, v147
    s_waitcnt vmcnt(12)
    v_lshlrev_b32 v136, 16, v124
    v_and_b32 v137, 0xffff0000, v124
    v_dot2_f32_bf16 v128, v100, s20, v136
    v_cvt_pk_bf16_f32 v156, v138, v139
    v_dot2_f32_bf16 v129, v104, s20, v136
    v_cvt_pk_bf16_f32 v157, v140, v141
    v_dot2_f32_bf16 v130, v108, s20, v136
    v_cvt_pk_bf16_f32 v158, v142, v143
    v_dot2_f32_bf16 v131, v112, s20, v136
    v_cvt_pk_bf16_f32 v159, v144, v145
    v_mfma_f32_16x16x16_bf16 v[168:171], a[124:125], a[148:149], v[168:171]
    v_mfma_f32_16x16x16_bf16 v[172:175], a[126:127], a[148:149], v[172:175]
    ds_write_b128 v217, v[156:159] offset:7168
    global_load_dwordx4 v[44:47], v207, s[10:11] offset:1280 nt
    v_dot2_f32_bf16 v132, v100, s21, v137
    v_dot2_f32_bf16 v133, v104, s21, v137
    v_dot2_f32_bf16 v134, v108, s21, v137
    v_dot2_f32_bf16 v135, v112, s21, v137
    v_lshlrev_b32 v146, 16, v125
    v_and_b32 v147, 0xffff0000, v125
    v_dot2_f32_bf16 v138, v101, s20, v146
    v_cvt_pk_bf16_f32 v152, v128, v129
    v_dot2_f32_bf16 v139, v105, s20, v146
    v_cvt_pk_bf16_f32 v153, v130, v131
    v_dot2_f32_bf16 v140, v109, s20, v146
    v_cvt_pk_bf16_f32 v154, v132, v133
    v_dot2_f32_bf16 v141, v113, s20, v146
    v_cvt_pk_bf16_f32 v155, v134, v135
    v_mfma_f32_16x16x16_bf16 v[176:179], a[128:129], a[148:149], v[176:179]
    v_mfma_f32_16x16x16_bf16 v[180:183], a[130:131], a[148:149], v[180:183]
    ds_write_b128 v217, v[152:155] offset:8192
    global_load_dwordx4 v[48:51], v207, s[12:13] offset:512 nt
    v_dot2_f32_bf16 v142, v101, s21, v147
    v_dot2_f32_bf16 v143, v105, s21, v147
    v_dot2_f32_bf16 v144, v109, s21, v147
    v_dot2_f32_bf16 v145, v113, s21, v147
    v_lshlrev_b32 v136, 16, v126
    v_and_b32 v137, 0xffff0000, v126
    v_dot2_f32_bf16 v128, v102, s20, v136
    v_cvt_pk_bf16_f32 v156, v138, v139
    v_dot2_f32_bf16 v129, v106, s20, v136
    v_cvt_pk_bf16_f32 v157, v140, v141
    v_dot2_f32_bf16 v130, v110, s20, v136
    v_cvt_pk_bf16_f32 v158, v142, v143
    v_dot2_f32_bf16 v131, v114, s20, v136
    v_cvt_pk_bf16_f32 v159, v144, v145
    v_mfma_f32_16x16x16_bf16 v[160:163], a[132:133], a[150:151], v[160:163]
    v_mfma_f32_16x16x16_bf16 v[164:167], a[134:135], a[150:151], v[164:167]
    ds_write_b128 v217, v[156:159] offset:9216
    global_load_dwordx4 v[52:55], v207, s[12:13] offset:1280 nt
    v_dot2_f32_bf16 v132, v102, s21, v137
    v_dot2_f32_bf16 v133, v106, s21, v137
    v_dot2_f32_bf16 v134, v110, s21, v137
    v_dot2_f32_bf16 v135, v114, s21, v137
    v_lshlrev_b32 v146, 16, v127
    v_and_b32 v147, 0xffff0000, v127
    v_dot2_f32_bf16 v138, v103, s20, v146
    v_cvt_pk_bf16_f32 v152, v128, v129
    v_dot2_f32_bf16 v139, v107, s20, v146
    v_cvt_pk_bf16_f32 v153, v130, v131
    v_dot2_f32_bf16 v140, v111, s20, v146
    v_cvt_pk_bf16_f32 v154, v132, v133
    v_dot2_f32_bf16 v141, v115, s20, v146
    v_cvt_pk_bf16_f32 v155, v134, v135
    v_mfma_f32_16x16x16_bf16 v[168:171], a[136:137], a[150:151], v[168:171]
    v_mfma_f32_16x16x16_bf16 v[172:175], a[138:139], a[150:151], v[172:175]
    ds_write_b128 v217, v[152:155] offset:10240
    v_dot2_f32_bf16 v142, v103, s21, v147
    v_dot2_f32_bf16 v143, v107, s21, v147
    v_dot2_f32_bf16 v144, v111, s21, v147
    v_dot2_f32_bf16 v145, v115, s21, v147
    s_nop 0
    v_cvt_pk_bf16_f32 v156, v138, v139
    v_cvt_pk_bf16_f32 v157, v140, v141
    v_cvt_pk_bf16_f32 v158, v142, v143
    v_cvt_pk_bf16_f32 v159, v144, v145
    v_mfma_f32_16x16x16_bf16 v[176:179], a[140:141], a[150:151], v[176:179]
    v_mfma_f32_16x16x16_bf16 v[180:183], a[142:143], a[150:151], v[180:183]
    ds_write_b128 v217, v[156:159] offset:11264
    v_add_u32 v218, 49152, v210
    v_add_u32 v219, 49152, v211
    v_add_u32 v220, 49152, v212
    ds_read_b64_tr_b16 a[48:49], v218 offset:0
    ds_read_b64_tr_b16 a[50:51], v219 offset:0
    ds_read_b64_tr_b16 a[52:53], v218 offset:1024
    ds_read_b64_tr_b16 a[54:55], v219 offset:1024
    ds_read_b64_tr_b16 a[56:57], v218 offset:2048
    ds_read_b64_tr_b16 a[58:59], v219 offset:2048
    ds_read_b64_tr_b16 a[60:61], v218 offset:3072
    ds_read_b64_tr_b16 a[62:63], v219 offset:3072
    ds_read_b64_tr_b16 a[64:65], v218 offset:4096
    ds_read_b64_tr_b16 a[66:67], v219 offset:4096
    ds_read_b64_tr_b16 a[68:69], v218 offset:5120
    ds_read_b64_tr_b16 a[70:71], v219 offset:5120
    ds_read_b64_tr_b16 a[72:73], v218 offset:6144
    ds_read_b64_tr_b16 a[74:75], v219 offset:6144
    ds_read_b64_tr_b16 a[76:77], v218 offset:7168
    ds_read_b64_tr_b16 a[78:79], v219 offset:7168
    ds_read_b64_tr_b16 a[80:81], v218 offset:8192
    ds_read_b64_tr_b16 a[82:83], v219 offset:8192
    ds_read_b64_tr_b16 a[84:85], v218 offset:9216
    ds_read_b64_tr_b16 a[86:87], v219 offset:9216
    ds_read_b64_tr_b16 a[88:89], v218 offset:10240
    ds_read_b64_tr_b16 a[90:91], v219 offset:10240
    ds_read_b64_tr_b16 a[92:93], v218 offset:11264
    ds_read_b64_tr_b16 a[94:95], v219 offset:11264
    s_waitcnt lgkmcnt(15)
    v_mfma_f32_16x16x32_bf16 v[192:195], a[48:51], a[48:51], 0
    ds_read_b128 a[96:99], v220 offset:0
    v_mfma_f32_16x16x32_bf16 v[192:195], a[52:55], a[52:55], v[192:195]
    ds_read_b128 a[100:103], v220 offset:4096
    s_mul_hi_u32 s34, s19, 89478486
    s_mul_i32 s35, s34, 48
    s_sub_u32 s35, s19, s35
    s_mul_i32 s34, s34, 589824
    s_mul_i32 s35, s35, 6144
    s_add_u32 s34, s34, s35
    s_add_u32 s44, s4, s34
    s_addc_u32 s45, s5, 0
    s_add_u32 s46, s44, 294912
    s_addc_u32 s47, s45, 0
    s_mul_i32 s34, s19, 3072
    s_add_u32 s48, s6, s34
    s_addc_u32 s49, s7, 0
    s_add_u32 s19, s19, 4
    global_load_dwordx4 v[116:119], v208, s[48:49] offset:0 nt
    v_mfma_f32_16x16x32_bf16 v[192:195], a[56:59], a[56:59], v[192:195]
    ds_read_b128 a[104:107], v220 offset:8192
    s_waitcnt lgkmcnt(15)
    v_mfma_f32_16x16x32_bf16 v[192:195], a[60:63], a[60:63], v[192:195]
    ds_read_b128 a[108:111], v220 offset:12288
    global_load_dwordx4 v[68:71], v207, s[44:45] offset:0 nt
    v_mfma_f32_16x16x32_bf16 v[192:195], a[64:67], a[64:67], v[192:195]
    ds_read_b128 a[112:115], v220 offset:16384
    v_mfma_f32_16x16x32_bf16 v[192:195], a[68:71], a[68:71], v[192:195]
    ds_read_b128 a[116:119], v220 offset:20480
    global_load_dwordx4 v[72:75], v207, s[44:45] offset:768 nt
    s_waitcnt lgkmcnt(12)
    v_mfma_f32_16x16x32_bf16 v[192:195], a[72:75], a[72:75], v[192:195]
    ds_read_b128 a[120:123], v220 offset:24576
    v_mfma_f32_16x16x32_bf16 v[192:195], a[76:79], a[76:79], v[192:195]
    ds_read_b128 a[124:127], v220 offset:28672
    global_load_dwordx4 v[76:79], v207, s[46:47] offset:0 nt
    v_mfma_f32_16x16x32_bf16 v[192:195], a[80:83], a[80:83], v[192:195]
    ds_read_b128 a[128:131], v220 offset:32768
    s_waitcnt lgkmcnt(9)
    v_mfma_f32_16x16x32_bf16 v[192:195], a[84:87], a[84:87], v[192:195]
    ds_read_b128 a[132:135], v220 offset:36864
    global_load_dwordx4 v[80:83], v207, s[46:47] offset:768 nt
    v_mfma_f32_16x16x32_bf16 v[192:195], a[88:91], a[88:91], v[192:195]
    ds_read_b128 a[136:139], v220 offset:40960
    v_mfma_f32_16x16x32_bf16 v[192:195], a[92:95], a[92:95], v[192:195]
    ds_read_b128 a[140:143], v220 offset:45056
    v_mfma_f32_16x16x32_bf16 v[188:191], a[48:51], a[152:155], 0
    v_mfma_f32_16x16x32_bf16 v[188:191], a[52:55], a[152:155], v[188:191]
    v_mfma_f32_16x16x32_bf16 v[188:191], a[56:59], a[152:155], v[188:191]
    v_mfma_f32_16x16x32_bf16 v[188:191], a[60:63], a[152:155], v[188:191]
    v_mfma_f32_16x16x32_bf16 v[188:191], a[64:67], a[152:155], v[188:191]
    v_mfma_f32_16x16x32_bf16 v[188:191], a[68:71], a[152:155], v[188:191]
    v_mfma_f32_16x16x32_bf16 v[188:191], a[72:75], a[152:155], v[188:191]
    v_mfma_f32_16x16x32_bf16 v[188:191], a[76:79], a[152:155], v[188:191]
    v_cndmask_b32 v128, 0, v192, s[26:27]
    v_mfma_f32_16x16x32_bf16 v[188:191], a[80:83], a[152:155], v[188:191]
    v_cndmask_b32 v128, v128, v193, s[28:29]
    v_mfma_f32_16x16x32_bf16 v[188:191], a[84:87], a[152:155], v[188:191]
    v_cndmask_b32 v128, v128, v194, s[30:31]
    v_mfma_f32_16x16x32_bf16 v[188:191], a[88:91], a[152:155], v[188:191]
    v_cndmask_b32 v128, v128, v195, s[32:33]
    v_mfma_f32_16x16x32_bf16 v[188:191], a[92:95], a[152:155], v[188:191]
    v_mfma_f32_16x16x32_bf16 v[184:187], a[48:51], a[0:3], 0
    v_mfma_f32_16x16x4_f32 v[196:199], v128, v205, 0
    v_mfma_f32_16x16x32_bf16 v[184:187], a[52:55], a[4:7], v[184:187]
    v_mfma_f32_16x16x32_bf16 v[184:187], a[56:59], a[8:11], v[184:187]
    v_mfma_f32_16x16x32_bf16 v[184:187], a[60:63], a[12:15], v[184:187]
    v_mfma_f32_16x16x32_bf16 v[184:187], a[64:67], a[16:19], v[184:187]
    v_mfma_f32_16x16x32_bf16 v[184:187], a[68:71], a[20:23], v[184:187]
    v_mfma_f32_16x16x32_bf16 v[184:187], a[72:75], a[24:27], v[184:187]
    v_mul_f32 v188, s23, v188
    v_mfma_f32_16x16x32_bf16 v[184:187], a[76:79], a[28:31], v[184:187]
    v_mul_f32 v189, s23, v189
    v_mfma_f32_16x16x32_bf16 v[184:187], a[80:83], a[32:35], v[184:187]
    v_mul_f32 v190, s23, v190
    v_mfma_f32_16x16x32_bf16 v[184:187], a[84:87], a[36:39], v[184:187]
    v_mul_f32 v191, s23, v191
    v_mfma_f32_16x16x32_bf16 v[184:187], a[88:91], a[40:43], v[184:187]
    v_fma_f32 v128, -v188, v188, v206
    v_fma_f32 v129, -v189, v189, v206
    v_mfma_f32_16x16x32_bf16 v[184:187], a[92:95], a[44:47], v[184:187]
    v_fma_f32 v130, -v190, v190, v206
    v_fma_f32 v131, -v191, v191, v206
    v_fma_f32 v196, v196, s23, v128
    v_fma_f32 v197, v197, s23, v129
    v_fma_f32 v198, v198, s23, v130
    v_fma_f32 v199, v199, s23, v131
    v_rsq_f32 v196, v196
    v_rsq_f32 v197, v197
    v_rsq_f32 v198, v198
    v_rsq_f32 v199, v199
    v_pk_fma_f32 v[184:185], v[188:189], v[204:205], v[184:185] op_sel_hi:[1,0,1] neg_lo:[1,0,0] neg_hi:[1,0,0]
    v_pk_fma_f32 v[186:187], v[190:191], v[204:205], v[186:187] op_sel_hi:[1,0,1] neg_lo:[1,0,0] neg_hi:[1,0,0]
    v_pk_fma_f32 v[136:137], v[184:185], v[196:197], v[202:203] op_sel_hi:[1,1,0] neg_lo:[0,0,1] neg_hi:[0,0,1]
    v_pk_fma_f32 v[138:139], v[186:187], v[198:199], v[202:203] op_sel_hi:[1,1,0] neg_lo:[0,0,1] neg_hi:[0,0,1]
    v_max3_f32 v128, v136, v137, v138
    v_max_f32 v128, v128, v139
    v_cmp_lt_f32 vcc, s61, v128
    v_exp_f32 v136, v136
    v_exp_f32 v137, v137
    v_exp_f32 v138, v138
    v_exp_f32 v139, v139
    s_nop 0
    v_pk_mul_f32 v[132:133], v[136:137], v[196:197]
    v_pk_mul_f32 v[134:135], v[138:139], v[198:199]
    v_cvt_pk_bf16_f32 v200, v132, v133
    v_cvt_pk_bf16_f32 v201, v134, v135
    ds_write_b64 v213, v[200:201] offset:0
    v_cndmask_b32 v128, 0, 1, vcc
    ds_write_b32 v254, v128 offset:0
    v_add_f32 v136, v136, v137
    v_add_f32 v138, v138, v139
    v_lshlrev_b32 v132, 16, v200
    v_and_b32 v133, 0xffff0000, v200
    v_lshlrev_b32 v134, 16, v201
    v_and_b32 v135, 0xffff0000, v201
    v_add_f32 v140, v136, v138
    v_mul_f32 v141, v132, v188
    v_mul_f32 v132, v133, v189
    v_fmac_f32 v141, v134, v190
    v_fmac_f32 v132, v135, v191
    v_add_f32 v141, v141, v132
    s_waitcnt lgkmcnt(0)
    s_barrier
    ds_read_b128 v[128:131], v255 offset:0
    ds_read_b64 a[144:145], v214 offset:0
    ds_read_b64 a[146:147], v214 offset:512
    ds_read_b64 a[148:149], v214 offset:1024
    ds_read_b64 a[150:151], v214 offset:1536
    s_waitcnt lgkmcnt(4)
    v_or3_b32 v128, v128, v129, v130
    v_or_b32 v128, v128, v131
    v_cmp_ne_u32 vcc, 0, v128
    s_cbranch_vccz BJ_25
    v_mul_f32 v136, v184, v196
    v_mul_f32 v137, v185, v197
    v_mul_f32 v138, v186, v198
    v_mul_f32 v139, v187, v199
    v_max3_f32 v128, v136, v137, v138
    v_max_f32 v128, v128, v139
    ds_max_f32 v215, v128
    s_waitcnt lgkmcnt(0)
    s_barrier
    ds_read_b32 v129, v215
    s_waitcnt lgkmcnt(0)
    v_sub_f32 v130, v202, v129
    v_sub_f32 v136, v136, v129
    v_sub_f32 v137, v137, v129
    v_sub_f32 v138, v138, v129
    v_sub_f32 v139, v139, v129
    v_exp_f32 v130, v130
    v_mov_b32 v202, v129
    v_exp_f32 v136, v136
    v_exp_f32 v137, v137
    v_exp_f32 v138, v138
    v_exp_f32 v139, v139
    s_nop 0
    v_pk_mul_f32 v[132:133], v[136:137], v[196:197]
    v_pk_mul_f32 v[134:135], v[138:139], v[198:199]
    v_cvt_pk_bf16_f32 v200, v132, v133
    v_cvt_pk_bf16_f32 v201, v134, v135
    ds_write_b64 v213, v[200:201] offset:0
    v_mul_f32 v203, v203, v130
    v_mul_f32 v221, v221, v130
    v_pk_mul_f32 v[160:161], v[160:161], v[130:131] op_sel_hi:[1,0]
    v_pk_mul_f32 v[162:163], v[162:163], v[130:131] op_sel_hi:[1,0]
    v_pk_mul_f32 v[164:165], v[164:165], v[130:131] op_sel_hi:[1,0]
    v_pk_mul_f32 v[166:167], v[166:167], v[130:131] op_sel_hi:[1,0]
    v_pk_mul_f32 v[168:169], v[168:169], v[130:131] op_sel_hi:[1,0]
    v_pk_mul_f32 v[170:171], v[170:171], v[130:131] op_sel_hi:[1,0]
    v_pk_mul_f32 v[172:173], v[172:173], v[130:131] op_sel_hi:[1,0]
    v_pk_mul_f32 v[174:175], v[174:175], v[130:131] op_sel_hi:[1,0]
    v_pk_mul_f32 v[176:177], v[176:177], v[130:131] op_sel_hi:[1,0]
    v_pk_mul_f32 v[178:179], v[178:179], v[130:131] op_sel_hi:[1,0]
    v_pk_mul_f32 v[180:181], v[180:181], v[130:131] op_sel_hi:[1,0]
    v_pk_mul_f32 v[182:183], v[182:183], v[130:131] op_sel_hi:[1,0]
    v_add_f32 v136, v136, v137
    v_add_f32 v138, v138, v139
    v_lshlrev_b32 v132, 16, v200
    v_and_b32 v133, 0xffff0000, v200
    v_lshlrev_b32 v134, 16, v201
    v_and_b32 v135, 0xffff0000, v201
    v_add_f32 v140, v136, v138
    v_mul_f32 v141, v132, v188
    v_mul_f32 v132, v133, v189
    v_fmac_f32 v141, v134, v190
    v_fmac_f32 v132, v135, v191
    v_add_f32 v141, v141, v132
    s_waitcnt lgkmcnt(0)
    s_barrier
    ds_read_b64 a[144:145], v214 offset:0
    ds_read_b64 a[146:147], v214 offset:512
    ds_read_b64 a[148:149], v214 offset:1024
    ds_read_b64 a[150:151], v214 offset:1536
BJ_25:
    v_add_f32 v203, v203, v140
    v_add_f32 v221, v221, v141
    v_add_u32 v218, 98304, v210
    v_add_u32 v219, 98304, v211
    v_add_u32 v220, 98304, v212
    s_waitcnt lgkmcnt(0)
    ds_read_b64_tr_b16 a[48:49], v218 offset:0
    v_mfma_f32_16x16x16_bf16 v[160:163], a[96:97], a[144:145], v[160:163]
    ds_read_b64_tr_b16 a[50:51], v219 offset:0
    v_mfma_f32_16x16x16_bf16 v[164:167], a[98:99], a[144:145], v[164:167]
    ds_read_b64_tr_b16 a[52:53], v218 offset:1024
    v_mfma_f32_16x16x16_bf16 v[168:171], a[100:101], a[144:145], v[168:171]
    ds_read_b64_tr_b16 a[54:55], v219 offset:1024
    v_mfma_f32_16x16x16_bf16 v[172:175], a[102:103], a[144:145], v[172:175]
    ds_read_b64_tr_b16 a[56:57], v218 offset:2048
    v_mfma_f32_16x16x16_bf16 v[176:179], a[104:105], a[144:145], v[176:179]
    ds_read_b64_tr_b16 a[58:59], v219 offset:2048
    v_mfma_f32_16x16x16_bf16 v[180:183], a[106:107], a[144:145], v[180:183]
    ds_read_b64_tr_b16 a[60:61], v218 offset:3072
    v_mfma_f32_16x16x16_bf16 v[160:163], a[108:109], a[146:147], v[160:163]
    ds_read_b64_tr_b16 a[62:63], v219 offset:3072
    v_mfma_f32_16x16x16_bf16 v[164:167], a[110:111], a[146:147], v[164:167]
    ds_read_b64_tr_b16 a[64:65], v218 offset:4096
    v_mfma_f32_16x16x16_bf16 v[168:171], a[112:113], a[146:147], v[168:171]
    ds_read_b64_tr_b16 a[66:67], v219 offset:4096
    v_mfma_f32_16x16x16_bf16 v[172:175], a[114:115], a[146:147], v[172:175]
    ds_read_b64_tr_b16 a[68:69], v218 offset:5120
    v_mfma_f32_16x16x16_bf16 v[176:179], a[116:117], a[146:147], v[176:179]
    ds_read_b64_tr_b16 a[70:71], v219 offset:5120
    v_mfma_f32_16x16x16_bf16 v[180:183], a[118:119], a[146:147], v[180:183]
    ds_read_b64_tr_b16 a[72:73], v218 offset:6144
    v_mfma_f32_16x16x16_bf16 v[160:163], a[120:121], a[148:149], v[160:163]
    ds_read_b64_tr_b16 a[74:75], v219 offset:6144
    v_mfma_f32_16x16x16_bf16 v[164:167], a[122:123], a[148:149], v[164:167]
    ds_read_b64_tr_b16 a[76:77], v218 offset:7168
    v_mfma_f32_16x16x16_bf16 v[168:171], a[124:125], a[148:149], v[168:171]
    ds_read_b64_tr_b16 a[78:79], v219 offset:7168
    v_mfma_f32_16x16x16_bf16 v[172:175], a[126:127], a[148:149], v[172:175]
    ds_read_b64_tr_b16 a[80:81], v218 offset:8192
    v_mfma_f32_16x16x16_bf16 v[176:179], a[128:129], a[148:149], v[176:179]
    ds_read_b64_tr_b16 a[82:83], v219 offset:8192
    v_mfma_f32_16x16x16_bf16 v[180:183], a[130:131], a[148:149], v[180:183]
    ds_read_b64_tr_b16 a[84:85], v218 offset:9216
    v_mfma_f32_16x16x16_bf16 v[160:163], a[132:133], a[150:151], v[160:163]
    ds_read_b64_tr_b16 a[86:87], v219 offset:9216
    v_mfma_f32_16x16x16_bf16 v[164:167], a[134:135], a[150:151], v[164:167]
    ds_read_b64_tr_b16 a[88:89], v218 offset:10240
    v_mfma_f32_16x16x16_bf16 v[168:171], a[136:137], a[150:151], v[168:171]
    ds_read_b64_tr_b16 a[90:91], v219 offset:10240
    v_mfma_f32_16x16x16_bf16 v[172:175], a[138:139], a[150:151], v[172:175]
    ds_read_b64_tr_b16 a[92:93], v218 offset:11264
    v_mfma_f32_16x16x16_bf16 v[176:179], a[140:141], a[150:151], v[176:179]
    ds_read_b64_tr_b16 a[94:95], v219 offset:11264
    v_mfma_f32_16x16x16_bf16 v[180:183], a[142:143], a[150:151], v[180:183]
    s_waitcnt lgkmcnt(15)
    v_mfma_f32_16x16x32_bf16 v[192:195], a[48:51], a[48:51], 0
    ds_read_b128 a[96:99], v220 offset:0
    v_mfma_f32_16x16x32_bf16 v[192:195], a[52:55], a[52:55], v[192:195]
    ds_read_b128 a[100:103], v220 offset:4096
    global_load_dwordx4 v[120:123], v208, s[48:49] offset:256 nt
    v_mfma_f32_16x16x32_bf16 v[192:195], a[56:59], a[56:59], v[192:195]
    ds_read_b128 a[104:107], v220 offset:8192
    s_waitcnt lgkmcnt(15)
    v_mfma_f32_16x16x32_bf16 v[192:195], a[60:63], a[60:63], v[192:195]
    ds_read_b128 a[108:111], v220 offset:12288
    global_load_dwordx4 v[84:87], v207, s[44:45] offset:256 nt
    v_mfma_f32_16x16x32_bf16 v[192:195], a[64:67], a[64:67], v[192:195]
    ds_read_b128 a[112:115], v220 offset:16384
    v_mfma_f32_16x16x32_bf16 v[192:195], a[68:71], a[68:71], v[192:195]
    ds_read_b128 a[116:119], v220 offset:20480
    global_load_dwordx4 v[88:91], v207, s[44:45] offset:1024 nt
    s_waitcnt lgkmcnt(12)
    v_mfma_f32_16x16x32_bf16 v[192:195], a[72:75], a[72:75], v[192:195]
    ds_read_b128 a[120:123], v220 offset:24576
    v_mfma_f32_16x16x32_bf16 v[192:195], a[76:79], a[76:79], v[192:195]
    ds_read_b128 a[124:127], v220 offset:28672
    global_load_dwordx4 v[92:95], v207, s[46:47] offset:256 nt
    v_mfma_f32_16x16x32_bf16 v[192:195], a[80:83], a[80:83], v[192:195]
    ds_read_b128 a[128:131], v220 offset:32768
    s_waitcnt lgkmcnt(9)
    v_mfma_f32_16x16x32_bf16 v[192:195], a[84:87], a[84:87], v[192:195]
    ds_read_b128 a[132:135], v220 offset:36864
    global_load_dwordx4 v[96:99], v207, s[46:47] offset:1024 nt
    v_mfma_f32_16x16x32_bf16 v[192:195], a[88:91], a[88:91], v[192:195]
    ds_read_b128 a[136:139], v220 offset:40960
    v_mfma_f32_16x16x32_bf16 v[192:195], a[92:95], a[92:95], v[192:195]
    ds_read_b128 a[140:143], v220 offset:45056
    v_mfma_f32_16x16x32_bf16 v[188:191], a[48:51], a[152:155], 0
    v_mfma_f32_16x16x32_bf16 v[188:191], a[52:55], a[152:155], v[188:191]
    v_mfma_f32_16x16x32_bf16 v[188:191], a[56:59], a[152:155], v[188:191]
    v_mfma_f32_16x16x32_bf16 v[188:191], a[60:63], a[152:155], v[188:191]
    v_mfma_f32_16x16x32_bf16 v[188:191], a[64:67], a[152:155], v[188:191]
    v_mfma_f32_16x16x32_bf16 v[188:191], a[68:71], a[152:155], v[188:191]
    v_mfma_f32_16x16x32_bf16 v[188:191], a[72:75], a[152:155], v[188:191]
    v_mfma_f32_16x16x32_bf16 v[188:191], a[76:79], a[152:155], v[188:191]
    v_cndmask_b32 v128, 0, v192, s[26:27]
    v_mfma_f32_16x16x32_bf16 v[188:191], a[80:83], a[152:155], v[188:191]
    v_cndmask_b32 v128, v128, v193, s[28:29]
    v_mfma_f32_16x16x32_bf16 v[188:191], a[84:87], a[152:155], v[188:191]
    v_cndmask_b32 v128, v128, v194, s[30:31]
    v_mfma_f32_16x16x32_bf16 v[188:191], a[88:91], a[152:155], v[188:191]
    v_cndmask_b32 v128, v128, v195, s[32:33]
    v_mfma_f32_16x16x32_bf16 v[188:191], a[92:95], a[152:155], v[188:191]
    v_mfma_f32_16x16x32_bf16 v[184:187], a[48:51], a[0:3], 0
    v_mfma_f32_16x16x4_f32 v[196:199], v128, v205, 0
    v_mfma_f32_16x16x32_bf16 v[184:187], a[52:55], a[4:7], v[184:187]
    v_mfma_f32_16x16x32_bf16 v[184:187], a[56:59], a[8:11], v[184:187]
    v_mfma_f32_16x16x32_bf16 v[184:187], a[60:63], a[12:15], v[184:187]
    v_mfma_f32_16x16x32_bf16 v[184:187], a[64:67], a[16:19], v[184:187]
    v_mfma_f32_16x16x32_bf16 v[184:187], a[68:71], a[20:23], v[184:187]
    v_mfma_f32_16x16x32_bf16 v[184:187], a[72:75], a[24:27], v[184:187]
    v_mul_f32 v188, s23, v188
    v_mfma_f32_16x16x32_bf16 v[184:187], a[76:79], a[28:31], v[184:187]
    v_mul_f32 v189, s23, v189
    v_mfma_f32_16x16x32_bf16 v[184:187], a[80:83], a[32:35], v[184:187]
    v_mul_f32 v190, s23, v190
    v_mfma_f32_16x16x32_bf16 v[184:187], a[84:87], a[36:39], v[184:187]
    v_mul_f32 v191, s23, v191
    v_mfma_f32_16x16x32_bf16 v[184:187], a[88:91], a[40:43], v[184:187]
    v_fma_f32 v128, -v188, v188, v206
    v_fma_f32 v129, -v189, v189, v206
    v_mfma_f32_16x16x32_bf16 v[184:187], a[92:95], a[44:47], v[184:187]
    v_fma_f32 v130, -v190, v190, v206
    v_fma_f32 v131, -v191, v191, v206
    v_fma_f32 v196, v196, s23, v128
    v_fma_f32 v197, v197, s23, v129
    v_fma_f32 v198, v198, s23, v130
    v_fma_f32 v199, v199, s23, v131
    v_rsq_f32 v196, v196
    v_rsq_f32 v197, v197
    v_rsq_f32 v198, v198
    v_rsq_f32 v199, v199
    v_pk_fma_f32 v[184:185], v[188:189], v[204:205], v[184:185] op_sel_hi:[1,0,1] neg_lo:[1,0,0] neg_hi:[1,0,0]
    v_pk_fma_f32 v[186:187], v[190:191], v[204:205], v[186:187] op_sel_hi:[1,0,1] neg_lo:[1,0,0] neg_hi:[1,0,0]
    v_pk_fma_f32 v[136:137], v[184:185], v[196:197], v[202:203] op_sel_hi:[1,1,0] neg_lo:[0,0,1] neg_hi:[0,0,1]
    v_pk_fma_f32 v[138:139], v[186:187], v[198:199], v[202:203] op_sel_hi:[1,1,0] neg_lo:[0,0,1] neg_hi:[0,0,1]
    v_max3_f32 v128, v136, v137, v138
    v_max_f32 v128, v128, v139
    v_cmp_lt_f32 vcc, s61, v128
    v_exp_f32 v136, v136
    v_exp_f32 v137, v137
    v_exp_f32 v138, v138
    v_exp_f32 v139, v139
    s_nop 0
    v_pk_mul_f32 v[132:133], v[136:137], v[196:197]
    v_pk_mul_f32 v[134:135], v[138:139], v[198:199]
    v_cvt_pk_bf16_f32 v200, v132, v133
    v_cvt_pk_bf16_f32 v201, v134, v135
    ds_write_b64 v213, v[200:201] offset:12288
    v_cndmask_b32 v128, 0, 1, vcc
    ds_write_b32 v254, v128 offset:10816
    v_add_f32 v136, v136, v137
    v_add_f32 v138, v138, v139
    v_lshlrev_b32 v132, 16, v200
    v_and_b32 v133, 0xffff0000, v200
    v_lshlrev_b32 v134, 16, v201
    v_and_b32 v135, 0xffff0000, v201
    v_add_f32 v140, v136, v138
    v_mul_f32 v141, v132, v188
    v_mul_f32 v132, v133, v189
    v_fmac_f32 v141, v134, v190
    v_fmac_f32 v132, v135, v191
    v_add_f32 v141, v141, v132
    s_waitcnt lgkmcnt(0)
    s_barrier
    ds_read_b128 v[128:131], v255 offset:10816
    ds_read_b64 a[144:145], v214 offset:12288
    ds_read_b64 a[146:147], v214 offset:12800
    ds_read_b64 a[148:149], v214 offset:13312
    ds_read_b64 a[150:151], v214 offset:13824
    s_waitcnt lgkmcnt(4)
    v_or3_b32 v128, v128, v129, v130
    v_or_b32 v128, v128, v131
    v_cmp_ne_u32 vcc, 0, v128
    s_cbranch_vccz BJ_27
    v_mul_f32 v136, v184, v196
    v_mul_f32 v137, v185, v197
    v_mul_f32 v138, v186, v198
    v_mul_f32 v139, v187, v199
    v_max3_f32 v128, v136, v137, v138
    v_max_f32 v128, v128, v139
    ds_max_f32 v215, v128
    s_waitcnt lgkmcnt(0)
    s_barrier
    ds_read_b32 v129, v215
    s_waitcnt lgkmcnt(0)
    v_sub_f32 v130, v202, v129
    v_sub_f32 v136, v136, v129
    v_sub_f32 v137, v137, v129
    v_sub_f32 v138, v138, v129
    v_sub_f32 v139, v139, v129
    v_exp_f32 v130, v130
    v_mov_b32 v202, v129
    v_exp_f32 v136, v136
    v_exp_f32 v137, v137
    v_exp_f32 v138, v138
    v_exp_f32 v139, v139
    s_nop 0
    v_pk_mul_f32 v[132:133], v[136:137], v[196:197]
    v_pk_mul_f32 v[134:135], v[138:139], v[198:199]
    v_cvt_pk_bf16_f32 v200, v132, v133
    v_cvt_pk_bf16_f32 v201, v134, v135
    ds_write_b64 v213, v[200:201] offset:12288
    v_mul_f32 v203, v203, v130
    v_mul_f32 v221, v221, v130
    v_pk_mul_f32 v[160:161], v[160:161], v[130:131] op_sel_hi:[1,0]
    v_pk_mul_f32 v[162:163], v[162:163], v[130:131] op_sel_hi:[1,0]
    v_pk_mul_f32 v[164:165], v[164:165], v[130:131] op_sel_hi:[1,0]
    v_pk_mul_f32 v[166:167], v[166:167], v[130:131] op_sel_hi:[1,0]
    v_pk_mul_f32 v[168:169], v[168:169], v[130:131] op_sel_hi:[1,0]
    v_pk_mul_f32 v[170:171], v[170:171], v[130:131] op_sel_hi:[1,0]
    v_pk_mul_f32 v[172:173], v[172:173], v[130:131] op_sel_hi:[1,0]
    v_pk_mul_f32 v[174:175], v[174:175], v[130:131] op_sel_hi:[1,0]
    v_pk_mul_f32 v[176:177], v[176:177], v[130:131] op_sel_hi:[1,0]
    v_pk_mul_f32 v[178:179], v[178:179], v[130:131] op_sel_hi:[1,0]
    v_pk_mul_f32 v[180:181], v[180:181], v[130:131] op_sel_hi:[1,0]
    v_pk_mul_f32 v[182:183], v[182:183], v[130:131] op_sel_hi:[1,0]
    v_add_f32 v136, v136, v137
    v_add_f32 v138, v138, v139
    v_lshlrev_b32 v132, 16, v200
    v_and_b32 v133, 0xffff0000, v200
    v_lshlrev_b32 v134, 16, v201
    v_and_b32 v135, 0xffff0000, v201
    v_add_f32 v140, v136, v138
    v_mul_f32 v141, v132, v188
    v_mul_f32 v132, v133, v189
    v_fmac_f32 v141, v134, v190
    v_fmac_f32 v132, v135, v191
    v_add_f32 v141, v141, v132
    s_waitcnt lgkmcnt(0)
    s_barrier
    ds_read_b64 a[144:145], v214 offset:12288
    ds_read_b64 a[146:147], v214 offset:12800
    ds_read_b64 a[148:149], v214 offset:13312
    ds_read_b64 a[150:151], v214 offset:13824
BJ_27:
    v_add_f32 v203, v203, v140
    v_add_f32 v221, v221, v141
    v_add_u32 v217, 49152, v209
    s_waitcnt lgkmcnt(0)
    s_waitcnt vmcnt(20)
    v_lshlrev_b32 v136, 16, v56
    v_and_b32 v137, 0xffff0000, v56
    v_dot2_f32_bf16 v128, v8, s20, v136
    v_dot2_f32_bf16 v129, v12, s20, v136
    v_dot2_f32_bf16 v130, v16, s20, v136
    v_dot2_f32_bf16 v131, v20, s20, v136
    global_load_dwordx4 v[124:127], v208, s[48:49] offset:512 nt
    v_dot2_f32_bf16 v132, v8, s21, v137
    v_dot2_f32_bf16 v133, v12, s21, v137
    v_dot2_f32_bf16 v134, v16, s21, v137
    v_dot2_f32_bf16 v135, v20, s21, v137
    v_lshlrev_b32 v146, 16, v57
    v_and_b32 v147, 0xffff0000, v57
    v_dot2_f32_bf16 v138, v9, s20, v146
    v_cvt_pk_bf16_f32 v152, v128, v129
    v_dot2_f32_bf16 v139, v13, s20, v146
    v_cvt_pk_bf16_f32 v153, v130, v131
    v_dot2_f32_bf16 v140, v17, s20, v146
    v_cvt_pk_bf16_f32 v154, v132, v133
    v_dot2_f32_bf16 v141, v21, s20, v146
    v_cvt_pk_bf16_f32 v155, v134, v135
    v_mfma_f32_16x16x16_bf16 v[160:163], a[96:97], a[144:145], v[160:163]
    v_mfma_f32_16x16x16_bf16 v[164:167], a[98:99], a[144:145], v[164:167]
    ds_write_b128 v217, v[152:155] offset:0
    global_load_dwordx4 v[100:103], v207, s[44:45] offset:512 nt
    v_dot2_f32_bf16 v142, v9, s21, v147
    v_dot2_f32_bf16 v143, v13, s21, v147
    v_dot2_f32_bf16 v144, v17, s21, v147
    v_dot2_f32_bf16 v145, v21, s21, v147
    v_lshlrev_b32 v136, 16, v58
    v_and_b32 v137, 0xffff0000, v58
    v_dot2_f32_bf16 v128, v10, s20, v136
    v_cvt_pk_bf16_f32 v156, v138, v139
    v_dot2_f32_bf16 v129, v14, s20, v136
    v_cvt_pk_bf16_f32 v157, v140, v141
    v_dot2_f32_bf16 v130, v18, s20, v136
    v_cvt_pk_bf16_f32 v158, v142, v143
    v_dot2_f32_bf16 v131, v22, s20, v136
    v_cvt_pk_bf16_f32 v159, v144, v145
    v_mfma_f32_16x16x16_bf16 v[168:171], a[100:101], a[144:145], v[168:171]
    v_mfma_f32_16x16x16_bf16 v[172:175], a[102:103], a[144:145], v[172:175]
    ds_write_b128 v217, v[156:159] offset:1024
    global_load_dwordx4 v[104:107], v207, s[44:45] offset:1280 nt
    v_dot2_f32_bf16 v132, v10, s21, v137
    v_dot2_f32_bf16 v133, v14, s21, v137
    v_dot2_f32_bf16 v134, v18, s21, v137
    v_dot2_f32_bf16 v135, v22, s21, v137
    v_lshlrev_b32 v146, 16, v59
    v_and_b32 v147, 0xffff0000, v59
    v_dot2_f32_bf16 v138, v11, s20, v146
    v_cvt_pk_bf16_f32 v152, v128, v129
    v_dot2_f32_bf16 v139, v15, s20, v146
    v_cvt_pk_bf16_f32 v153, v130, v131
    v_dot2_f32_bf16 v140, v19, s20, v146
    v_cvt_pk_bf16_f32 v154, v132, v133
    v_dot2_f32_bf16 v141, v23, s20, v146
    v_cvt_pk_bf16_f32 v155, v134, v135
    v_mfma_f32_16x16x16_bf16 v[176:179], a[104:105], a[144:145], v[176:179]
    v_mfma_f32_16x16x16_bf16 v[180:183], a[106:107], a[144:145], v[180:183]
    ds_write_b128 v217, v[152:155] offset:2048
    global_load_dwordx4 v[108:111], v207, s[46:47] offset:512 nt
    v_dot2_f32_bf16 v142, v11, s21, v147
    v_dot2_f32_bf16 v143, v15, s21, v147
    v_dot2_f32_bf16 v144, v19, s21, v147
    v_dot2_f32_bf16 v145, v23, s21, v147
    s_waitcnt vmcnt(19)
    v_lshlrev_b32 v136, 16, v60
    v_and_b32 v137, 0xffff0000, v60
    v_dot2_f32_bf16 v128, v24, s20, v136
    v_cvt_pk_bf16_f32 v156, v138, v139
    v_dot2_f32_bf16 v129, v28, s20, v136
    v_cvt_pk_bf16_f32 v157, v140, v141
    v_dot2_f32_bf16 v130, v32, s20, v136
    v_cvt_pk_bf16_f32 v158, v142, v143
    v_dot2_f32_bf16 v131, v36, s20, v136
    v_cvt_pk_bf16_f32 v159, v144, v145
    v_mfma_f32_16x16x16_bf16 v[160:163], a[108:109], a[146:147], v[160:163]
    v_mfma_f32_16x16x16_bf16 v[164:167], a[110:111], a[146:147], v[164:167]
    ds_write_b128 v217, v[156:159] offset:3072
    global_load_dwordx4 v[112:115], v207, s[46:47] offset:1280 nt
    v_dot2_f32_bf16 v132, v24, s21, v137
    v_dot2_f32_bf16 v133, v28, s21, v137
    v_dot2_f32_bf16 v134, v32, s21, v137
    v_dot2_f32_bf16 v135, v36, s21, v137
    v_lshlrev_b32 v146, 16, v61
    v_and_b32 v147, 0xffff0000, v61
    v_dot2_f32_bf16 v138, v25, s20, v146
    v_cvt_pk_bf16_f32 v152, v128, v129
    v_dot2_f32_bf16 v139, v29, s20, v146
    v_cvt_pk_bf16_f32 v153, v130, v131
    v_dot2_f32_bf16 v140, v33, s20, v146
    v_cvt_pk_bf16_f32 v154, v132, v133
    v_dot2_f32_bf16 v141, v37, s20, v146
    v_cvt_pk_bf16_f32 v155, v134, v135
    v_mfma_f32_16x16x16_bf16 v[168:171], a[112:113], a[146:147], v[168:171]
    v_mfma_f32_16x16x16_bf16 v[172:175], a[114:115], a[146:147], v[172:175]
    ds_write_b128 v217, v[152:155] offset:4096
    v_dot2_f32_bf16 v142, v25, s21, v147
    v_dot2_f32_bf16 v143, v29, s21, v147
    v_dot2_f32_bf16 v144, v33, s21, v147
    v_dot2_f32_bf16 v145, v37, s21, v147
    v_lshlrev_b32 v136, 16, v62
    v_and_b32 v137, 0xffff0000, v62
    v_dot2_f32_bf16 v128, v26, s20, v136
    v_cvt_pk_bf16_f32 v156, v138, v139
    v_dot2_f32_bf16 v129, v30, s20, v136
    v_cvt_pk_bf16_f32 v157, v140, v141
    v_dot2_f32_bf16 v130, v34, s20, v136
    v_cvt_pk_bf16_f32 v158, v142, v143
    v_dot2_f32_bf16 v131, v38, s20, v136
    v_cvt_pk_bf16_f32 v159, v144, v145
    v_mfma_f32_16x16x16_bf16 v[176:179], a[116:117], a[146:147], v[176:179]
    v_mfma_f32_16x16x16_bf16 v[180:183], a[118:119], a[146:147], v[180:183]
    ds_write_b128 v217, v[156:159] offset:5120
    s_mul_hi_u32 s34, s19, 89478486
    s_mul_i32 s35, s34, 48
    s_sub_u32 s35, s19, s35
    s_mul_i32 s34, s34, 589824
    s_mul_i32 s35, s35, 6144
    s_add_u32 s34, s34, s35
    s_add_u32 s10, s4, s34
    s_addc_u32 s11, s5, 0
    s_add_u32 s12, s10, 294912
    s_addc_u32 s13, s11, 0
    s_mul_i32 s34, s19, 3072
    s_add_u32 s14, s6, s34
    s_addc_u32 s15, s7, 0
    s_add_u32 s19, s19, 4
    global_load_dwordx4 v[56:59], v208, s[14:15] offset:0 nt
    v_dot2_f32_bf16 v132, v26, s21, v137
    v_dot2_f32_bf16 v133, v30, s21, v137
    v_dot2_f32_bf16 v134, v34, s21, v137
    v_dot2_f32_bf16 v135, v38, s21, v137
    v_lshlrev_b32 v146, 16, v63
    v_and_b32 v147, 0xffff0000, v63
    v_dot2_f32_bf16 v138, v27, s20, v146
    v_cvt_pk_bf16_f32 v152, v128, v129
    v_dot2_f32_bf16 v139, v31, s20, v146
    v_cvt_pk_bf16_f32 v153, v130, v131
    v_dot2_f32_bf16 v140, v35, s20, v146
    v_cvt_pk_bf16_f32 v154, v132, v133
    v_dot2_f32_bf16 v141, v39, s20, v146
    v_cvt_pk_bf16_f32 v155, v134, v135
    v_mfma_f32_16x16x16_bf16 v[160:163], a[120:121], a[148:149], v[160:163]
    v_mfma_f32_16x16x16_bf16 v[164:167], a[122:123], a[148:149], v[164:167]
    ds_write_b128 v217, v[152:155] offset:6144
    global_load_dwordx4 v[8:11], v207, s[10:11] offset:0 nt
    v_dot2_f32_bf16 v142, v27, s21, v147
    v_dot2_f32_bf16 v143, v31, s21, v147
    v_dot2_f32_bf16 v144, v35, s21, v147
    v_dot2_f32_bf16 v145, v39, s21, v147
    s_waitcnt vmcnt(17)
    v_lshlrev_b32 v136, 16, v64
    v_and_b32 v137, 0xffff0000, v64
    v_dot2_f32_bf16 v128, v40, s20, v136
    v_cvt_pk_bf16_f32 v156, v138, v139
    v_dot2_f32_bf16 v129, v44, s20, v136
    v_cvt_pk_bf16_f32 v157, v140, v141
    v_dot2_f32_bf16 v130, v48, s20, v136
    v_cvt_pk_bf16_f32 v158, v142, v143
    v_dot2_f32_bf16 v131, v52, s20, v136
    v_cvt_pk_bf16_f32 v159, v144, v145
    v_mfma_f32_16x16x16_bf16 v[168:171], a[124:125], a[148:149], v[168:171]
    v_mfma_f32_16x16x16_bf16 v[172:175], a[126:127], a[148:149], v[172:175]
    ds_write_b128 v217, v[156:159] offset:7168
    global_load_dwordx4 v[12:15], v207, s[10:11] offset:768 nt
    v_dot2_f32_bf16 v132, v40, s21, v137
    v_dot2_f32_bf16 v133, v44, s21, v137
    v_dot2_f32_bf16 v134, v48, s21, v137
    v_dot2_f32_bf16 v135, v52, s21, v137
    v_lshlrev_b32 v146, 16, v65
    v_and_b32 v147, 0xffff0000, v65
    v_dot2_f32_bf16 v138, v41, s20, v146
    v_cvt_pk_bf16_f32 v152, v128, v129
    v_dot2_f32_bf16 v139, v45, s20, v146
    v_cvt_pk_bf16_f32 v153, v130, v131
    v_dot2_f32_bf16 v140, v49, s20, v146
    v_cvt_pk_bf16_f32 v154, v132, v133
    v_dot2_f32_bf16 v141, v53, s20, v146
    v_cvt_pk_bf16_f32 v155, v134, v135
    v_mfma_f32_16x16x16_bf16 v[176:179], a[128:129], a[148:149], v[176:179]
    v_mfma_f32_16x16x16_bf16 v[180:183], a[130:131], a[148:149], v[180:183]
    ds_write_b128 v217, v[152:155] offset:8192
    global_load_dwordx4 v[16:19], v207, s[12:13] offset:0 nt
    v_dot2_f32_bf16 v142, v41, s21, v147
    v_dot2_f32_bf16 v143, v45, s21, v147
    v_dot2_f32_bf16 v144, v49, s21, v147
    v_dot2_f32_bf16 v145, v53, s21, v147
    v_lshlrev_b32 v136, 16, v66
    v_and_b32 v137, 0xffff0000, v66
    v_dot2_f32_bf16 v128, v42, s20, v136
    v_cvt_pk_bf16_f32 v156, v138, v139
    v_dot2_f32_bf16 v129, v46, s20, v136
    v_cvt_pk_bf16_f32 v157, v140, v141
    v_dot2_f32_bf16 v130, v50, s20, v136
    v_cvt_pk_bf16_f32 v158, v142, v143
    v_dot2_f32_bf16 v131, v54, s20, v136
    v_cvt_pk_bf16_f32 v159, v144, v145
    v_mfma_f32_16x16x16_bf16 v[160:163], a[132:133], a[150:151], v[160:163]
    v_mfma_f32_16x16x16_bf16 v[164:167], a[134:135], a[150:151], v[164:167]
    ds_write_b128 v217, v[156:159] offset:9216
    global_load_dwordx4 v[20:23], v207, s[12:13] offset:768 nt
    v_dot2_f32_bf16 v132, v42, s21, v137
    v_dot2_f32_bf16 v133, v46, s21, v137
    v_dot2_f32_bf16 v134, v50, s21, v137
    v_dot2_f32_bf16 v135, v54, s21, v137
    v_lshlrev_b32 v146, 16, v67
    v_and_b32 v147, 0xffff0000, v67
    v_dot2_f32_bf16 v138, v43, s20, v146
    v_cvt_pk_bf16_f32 v152, v128, v129
    v_dot2_f32_bf16 v139, v47, s20, v146
    v_cvt_pk_bf16_f32 v153, v130, v131
    v_dot2_f32_bf16 v140, v51, s20, v146
    v_cvt_pk_bf16_f32 v154, v132, v133
    v_dot2_f32_bf16 v141, v55, s20, v146
    v_cvt_pk_bf16_f32 v155, v134, v135
    v_mfma_f32_16x16x16_bf16 v[168:171], a[136:137], a[150:151], v[168:171]
    v_mfma_f32_16x16x16_bf16 v[172:175], a[138:139], a[150:151], v[172:175]
    ds_write_b128 v217, v[152:155] offset:10240
    v_dot2_f32_bf16 v142, v43, s21, v147
    v_dot2_f32_bf16 v143, v47, s21, v147
    v_dot2_f32_bf16 v144, v51, s21, v147
    v_dot2_f32_bf16 v145, v55, s21, v147
    s_nop 0
    v_cvt_pk_bf16_f32 v156, v138, v139
    v_cvt_pk_bf16_f32 v157, v140, v141
    v_cvt_pk_bf16_f32 v158, v142, v143
    v_cvt_pk_bf16_f32 v159, v144, v145
    v_mfma_f32_16x16x16_bf16 v[176:179], a[140:141], a[150:151], v[176:179]
    v_mfma_f32_16x16x16_bf16 v[180:183], a[142:143], a[150:151], v[180:183]
    ds_write_b128 v217, v[156:159] offset:11264
    v_add_u32 v218, 0, v210
    v_add_u32 v219, 0, v211
    v_add_u32 v220, 0, v212
    ds_read_b64_tr_b16 a[48:49], v218 offset:0
    ds_read_b64_tr_b16 a[50:51], v219 offset:0
    ds_read_b64_tr_b16 a[52:53], v218 offset:1024
    ds_read_b64_tr_b16 a[54:55], v219 offset:1024
    ds_read_b64_tr_b16 a[56:57], v218 offset:2048
    ds_read_b64_tr_b16 a[58:59], v219 offset:2048
    ds_read_b64_tr_b16 a[60:61], v218 offset:3072
    ds_read_b64_tr_b16 a[62:63], v219 offset:3072
    ds_read_b64_tr_b16 a[64:65], v218 offset:4096
    ds_read_b64_tr_b16 a[66:67], v219 offset:4096
    ds_read_b64_tr_b16 a[68:69], v218 offset:5120
    ds_read_b64_tr_b16 a[70:71], v219 offset:5120
    ds_read_b64_tr_b16 a[72:73], v218 offset:6144
    ds_read_b64_tr_b16 a[74:75], v219 offset:6144
    ds_read_b64_tr_b16 a[76:77], v218 offset:7168
    ds_read_b64_tr_b16 a[78:79], v219 offset:7168
    ds_read_b64_tr_b16 a[80:81], v218 offset:8192
    ds_read_b64_tr_b16 a[82:83], v219 offset:8192
    ds_read_b64_tr_b16 a[84:85], v218 offset:9216
    ds_read_b64_tr_b16 a[86:87], v219 offset:9216
    ds_read_b64_tr_b16 a[88:89], v218 offset:10240
    ds_read_b64_tr_b16 a[90:91], v219 offset:10240
    ds_read_b64_tr_b16 a[92:93], v218 offset:11264
    ds_read_b64_tr_b16 a[94:95], v219 offset:11264
    s_waitcnt lgkmcnt(15)
    v_mfma_f32_16x16x32_bf16 v[192:195], a[48:51], a[48:51], 0
    ds_read_b128 a[96:99], v220 offset:0
    v_mfma_f32_16x16x32_bf16 v[192:195], a[52:55], a[52:55], v[192:195]
    ds_read_b128 a[100:103], v220 offset:4096
    global_load_dwordx4 v[60:63], v208, s[14:15] offset:256 nt
    v_mfma_f32_16x16x32_bf16 v[192:195], a[56:59], a[56:59], v[192:195]
    ds_read_b128 a[104:107], v220 offset:8192
    s_waitcnt lgkmcnt(15)
    v_mfma_f32_16x16x32_bf16 v[192:195], a[60:63], a[60:63], v[192:195]
    ds_read_b128 a[108:111], v220 offset:12288
    global_load_dwordx4 v[24:27], v207, s[10:11] offset:256 nt
    v_mfma_f32_16x16x32_bf16 v[192:195], a[64:67], a[64:67], v[192:195]
    ds_read_b128 a[112:115], v220 offset:16384
    v_mfma_f32_16x16x32_bf16 v[192:195], a[68:71], a[68:71], v[192:195]
    ds_read_b128 a[116:119], v220 offset:20480
    global_load_dwordx4 v[28:31], v207, s[10:11] offset:1024 nt
    s_waitcnt lgkmcnt(12)
    v_mfma_f32_16x16x32_bf16 v[192:195], a[72:75], a[72:75], v[192:195]
    ds_read_b128 a[120:123], v220 offset:24576
    v_mfma_f32_16x16x32_bf16 v[192:195], a[76:79], a[76:79], v[192:195]
    ds_read_b128 a[124:127], v220 offset:28672
    global_load_dwordx4 v[32:35], v207, s[12:13] offset:256 nt
    v_mfma_f32_16x16x32_bf16 v[192:195], a[80:83], a[80:83], v[192:195]
    ds_read_b128 a[128:131], v220 offset:32768
    s_waitcnt lgkmcnt(9)
    v_mfma_f32_16x16x32_bf16 v[192:195], a[84:87], a[84:87], v[192:195]
    ds_read_b128 a[132:135], v220 offset:36864
    global_load_dwordx4 v[36:39], v207, s[12:13] offset:1024 nt
    v_mfma_f32_16x16x32_bf16 v[192:195], a[88:91], a[88:91], v[192:195]
    ds_read_b128 a[136:139], v220 offset:40960
    v_mfma_f32_16x16x32_bf16 v[192:195], a[92:95], a[92:95], v[192:195]
    ds_read_b128 a[140:143], v220 offset:45056
    v_mfma_f32_16x16x32_bf16 v[188:191], a[48:51], a[152:155], 0
    v_mfma_f32_16x16x32_bf16 v[188:191], a[52:55], a[152:155], v[188:191]
    v_mfma_f32_16x16x32_bf16 v[188:191], a[56:59], a[152:155], v[188:191]
    v_mfma_f32_16x16x32_bf16 v[188:191], a[60:63], a[152:155], v[188:191]
    v_mfma_f32_16x16x32_bf16 v[188:191], a[64:67], a[152:155], v[188:191]
    v_mfma_f32_16x16x32_bf16 v[188:191], a[68:71], a[152:155], v[188:191]
    v_mfma_f32_16x16x32_bf16 v[188:191], a[72:75], a[152:155], v[188:191]
    v_mfma_f32_16x16x32_bf16 v[188:191], a[76:79], a[152:155], v[188:191]
    v_cndmask_b32 v128, 0, v192, s[26:27]
    v_mfma_f32_16x16x32_bf16 v[188:191], a[80:83], a[152:155], v[188:191]
    v_cndmask_b32 v128, v128, v193, s[28:29]
    v_mfma_f32_16x16x32_bf16 v[188:191], a[84:87], a[152:155], v[188:191]
    v_cndmask_b32 v128, v128, v194, s[30:31]
    v_mfma_f32_16x16x32_bf16 v[188:191], a[88:91], a[152:155], v[188:191]
    v_cndmask_b32 v128, v128, v195, s[32:33]
    v_mfma_f32_16x16x32_bf16 v[188:191], a[92:95], a[152:155], v[188:191]
    v_mfma_f32_16x16x32_bf16 v[184:187], a[48:51], a[0:3], 0
    v_mfma_f32_16x16x4_f32 v[196:199], v128, v205, 0
    v_mfma_f32_16x16x32_bf16 v[184:187], a[52:55], a[4:7], v[184:187]
    v_mfma_f32_16x16x32_bf16 v[184:187], a[56:59], a[8:11], v[184:187]
    v_mfma_f32_16x16x32_bf16 v[184:187], a[60:63], a[12:15], v[184:187]
    v_mfma_f32_16x16x32_bf16 v[184:187], a[64:67], a[16:19], v[184:187]
    v_mfma_f32_16x16x32_bf16 v[184:187], a[68:71], a[20:23], v[184:187]
    v_mfma_f32_16x16x32_bf16 v[184:187], a[72:75], a[24:27], v[184:187]
    v_mul_f32 v188, s23, v188
    v_mfma_f32_16x16x32_bf16 v[184:187], a[76:79], a[28:31], v[184:187]
    v_mul_f32 v189, s23, v189
    v_mfma_f32_16x16x32_bf16 v[184:187], a[80:83], a[32:35], v[184:187]
    v_mul_f32 v190, s23, v190
    v_mfma_f32_16x16x32_bf16 v[184:187], a[84:87], a[36:39], v[184:187]
    v_mul_f32 v191, s23, v191
    v_mfma_f32_16x16x32_bf16 v[184:187], a[88:91], a[40:43], v[184:187]
    v_fma_f32 v128, -v188, v188, v206
    v_fma_f32 v129, -v189, v189, v206
    v_mfma_f32_16x16x32_bf16 v[184:187], a[92:95], a[44:47], v[184:187]
    v_fma_f32 v130, -v190, v190, v206
    v_fma_f32 v131, -v191, v191, v206
    v_fma_f32 v196, v196, s23, v128
    v_fma_f32 v197, v197, s23, v129
    v_fma_f32 v198, v198, s23, v130
    v_fma_f32 v199, v199, s23, v131
    v_rsq_f32 v196, v196
    v_rsq_f32 v197, v197
    v_rsq_f32 v198, v198
    v_rsq_f32 v199, v199
    v_pk_fma_f32 v[184:185], v[188:189], v[204:205], v[184:185] op_sel_hi:[1,0,1] neg_lo:[1,0,0] neg_hi:[1,0,0]
    v_pk_fma_f32 v[186:187], v[190:191], v[204:205], v[186:187] op_sel_hi:[1,0,1] neg_lo:[1,0,0] neg_hi:[1,0,0]
    v_pk_fma_f32 v[136:137], v[184:185], v[196:197], v[202:203] op_sel_hi:[1,1,0] neg_lo:[0,0,1] neg_hi:[0,0,1]
    v_pk_fma_f32 v[138:139], v[186:187], v[198:199], v[202:203] op_sel_hi:[1,1,0] neg_lo:[0,0,1] neg_hi:[0,0,1]
    v_max3_f32 v128, v136, v137, v138
    v_max_f32 v128, v128, v139
    v_cmp_lt_f32 vcc, s61, v128
    v_exp_f32 v136, v136
    v_exp_f32 v137, v137
    v_exp_f32 v138, v138
    v_exp_f32 v139, v139
    s_nop 0
    v_pk_mul_f32 v[132:133], v[136:137], v[196:197]
    v_pk_mul_f32 v[134:135], v[138:139], v[198:199]
    v_cvt_pk_bf16_f32 v200, v132, v133
    v_cvt_pk_bf16_f32 v201, v134, v135
    ds_write_b64 v213, v[200:201] offset:0
    v_cndmask_b32 v128, 0, 1, vcc
    ds_write_b32 v254, v128 offset:0
    v_add_f32 v136, v136, v137
    v_add_f32 v138, v138, v139
    v_lshlrev_b32 v132, 16, v200
    v_and_b32 v133, 0xffff0000, v200
    v_lshlrev_b32 v134, 16, v201
    v_and_b32 v135, 0xffff0000, v201
    v_add_f32 v140, v136, v138
    v_mul_f32 v141, v132, v188
    v_mul_f32 v132, v133, v189
    v_fmac_f32 v141, v134, v190
    v_fmac_f32 v132, v135, v191
    v_add_f32 v141, v141, v132
    s_waitcnt lgkmcnt(0)
    s_barrier
    ds_read_b128 v[128:131], v255 offset:0
    ds_read_b64 a[144:145], v214 offset:0
    ds_read_b64 a[146:147], v214 offset:512
    ds_read_b64 a[148:149], v214 offset:1024
    ds_read_b64 a[150:151], v214 offset:1536
    s_waitcnt lgkmcnt(4)
    v_or3_b32 v128, v128, v129, v130
    v_or_b32 v128, v128, v131
    v_cmp_ne_u32 vcc, 0, v128
    s_cbranch_vccz BJ_29
    v_mul_f32 v136, v184, v196
    v_mul_f32 v137, v185, v197
    v_mul_f32 v138, v186, v198
    v_mul_f32 v139, v187, v199
    v_max3_f32 v128, v136, v137, v138
    v_max_f32 v128, v128, v139
    ds_max_f32 v215, v128
    s_waitcnt lgkmcnt(0)
    s_barrier
    ds_read_b32 v129, v215
    s_waitcnt lgkmcnt(0)
    v_sub_f32 v130, v202, v129
    v_sub_f32 v136, v136, v129
    v_sub_f32 v137, v137, v129
    v_sub_f32 v138, v138, v129
    v_sub_f32 v139, v139, v129
    v_exp_f32 v130, v130
    v_mov_b32 v202, v129
    v_exp_f32 v136, v136
    v_exp_f32 v137, v137
    v_exp_f32 v138, v138
    v_exp_f32 v139, v139
    s_nop 0
    v_pk_mul_f32 v[132:133], v[136:137], v[196:197]
    v_pk_mul_f32 v[134:135], v[138:139], v[198:199]
    v_cvt_pk_bf16_f32 v200, v132, v133
    v_cvt_pk_bf16_f32 v201, v134, v135
    ds_write_b64 v213, v[200:201] offset:0
    v_mul_f32 v203, v203, v130
    v_mul_f32 v221, v221, v130
    v_pk_mul_f32 v[160:161], v[160:161], v[130:131] op_sel_hi:[1,0]
    v_pk_mul_f32 v[162:163], v[162:163], v[130:131] op_sel_hi:[1,0]
    v_pk_mul_f32 v[164:165], v[164:165], v[130:131] op_sel_hi:[1,0]
    v_pk_mul_f32 v[166:167], v[166:167], v[130:131] op_sel_hi:[1,0]
    v_pk_mul_f32 v[168:169], v[168:169], v[130:131] op_sel_hi:[1,0]
    v_pk_mul_f32 v[170:171], v[170:171], v[130:131] op_sel_hi:[1,0]
    v_pk_mul_f32 v[172:173], v[172:173], v[130:131] op_sel_hi:[1,0]
    v_pk_mul_f32 v[174:175], v[174:175], v[130:131] op_sel_hi:[1,0]
    v_pk_mul_f32 v[176:177], v[176:177], v[130:131] op_sel_hi:[1,0]
    v_pk_mul_f32 v[178:179], v[178:179], v[130:131] op_sel_hi:[1,0]
    v_pk_mul_f32 v[180:181], v[180:181], v[130:131] op_sel_hi:[1,0]
    v_pk_mul_f32 v[182:183], v[182:183], v[130:131] op_sel_hi:[1,0]
    v_add_f32 v136, v136, v137
    v_add_f32 v138, v138, v139
    v_lshlrev_b32 v132, 16, v200
    v_and_b32 v133, 0xffff0000, v200
    v_lshlrev_b32 v134, 16, v201
    v_and_b32 v135, 0xffff0000, v201
    v_add_f32 v140, v136, v138
    v_mul_f32 v141, v132, v188
    v_mul_f32 v132, v133, v189
    v_fmac_f32 v141, v134, v190
    v_fmac_f32 v132, v135, v191
    v_add_f32 v141, v141, v132
    s_waitcnt lgkmcnt(0)
    s_barrier
    ds_read_b64 a[144:145], v214 offset:0
    ds_read_b64 a[146:147], v214 offset:512
    ds_read_b64 a[148:149], v214 offset:1024
    ds_read_b64 a[150:151], v214 offset:1536
BJ_29:
    v_add_f32 v203, v203, v140
    v_add_f32 v221, v221, v141
    v_add_u32 v218, 49152, v210
    v_add_u32 v219, 49152, v211
    v_add_u32 v220, 49152, v212
    s_waitcnt lgkmcnt(0)
    ds_read_b64_tr_b16 a[48:49], v218 offset:0
    v_mfma_f32_16x16x16_bf16 v[160:163], a[96:97], a[144:145], v[160:163]
    ds_read_b64_tr_b16 a[50:51], v219 offset:0
    v_mfma_f32_16x16x16_bf16 v[164:167], a[98:99], a[144:145], v[164:167]
    ds_read_b64_tr_b16 a[52:53], v218 offset:1024
    v_mfma_f32_16x16x16_bf16 v[168:171], a[100:101], a[144:145], v[168:171]
    ds_read_b64_tr_b16 a[54:55], v219 offset:1024
    v_mfma_f32_16x16x16_bf16 v[172:175], a[102:103], a[144:145], v[172:175]
    ds_read_b64_tr_b16 a[56:57], v218 offset:2048
    v_mfma_f32_16x16x16_bf16 v[176:179], a[104:105], a[144:145], v[176:179]
    ds_read_b64_tr_b16 a[58:59], v219 offset:2048
    v_mfma_f32_16x16x16_bf16 v[180:183], a[106:107], a[144:145], v[180:183]
    ds_read_b64_tr_b16 a[60:61], v218 offset:3072
    v_mfma_f32_16x16x16_bf16 v[160:163], a[108:109], a[146:147], v[160:163]
    ds_read_b64_tr_b16 a[62:63], v219 offset:3072
    v_mfma_f32_16x16x16_bf16 v[164:167], a[110:111], a[146:147], v[164:167]
    ds_read_b64_tr_b16 a[64:65], v218 offset:4096
    v_mfma_f32_16x16x16_bf16 v[168:171], a[112:113], a[146:147], v[168:171]
    ds_read_b64_tr_b16 a[66:67], v219 offset:4096
    v_mfma_f32_16x16x16_bf16 v[172:175], a[114:115], a[146:147], v[172:175]
    ds_read_b64_tr_b16 a[68:69], v218 offset:5120
    v_mfma_f32_16x16x16_bf16 v[176:179], a[116:117], a[146:147], v[176:179]
    ds_read_b64_tr_b16 a[70:71], v219 offset:5120
    v_mfma_f32_16x16x16_bf16 v[180:183], a[118:119], a[146:147], v[180:183]
    ds_read_b64_tr_b16 a[72:73], v218 offset:6144
    v_mfma_f32_16x16x16_bf16 v[160:163], a[120:121], a[148:149], v[160:163]
    ds_read_b64_tr_b16 a[74:75], v219 offset:6144
    v_mfma_f32_16x16x16_bf16 v[164:167], a[122:123], a[148:149], v[164:167]
    ds_read_b64_tr_b16 a[76:77], v218 offset:7168
    v_mfma_f32_16x16x16_bf16 v[168:171], a[124:125], a[148:149], v[168:171]
    ds_read_b64_tr_b16 a[78:79], v219 offset:7168
    v_mfma_f32_16x16x16_bf16 v[172:175], a[126:127], a[148:149], v[172:175]
    ds_read_b64_tr_b16 a[80:81], v218 offset:8192
    v_mfma_f32_16x16x16_bf16 v[176:179], a[128:129], a[148:149], v[176:179]
    ds_read_b64_tr_b16 a[82:83], v219 offset:8192
    v_mfma_f32_16x16x16_bf16 v[180:183], a[130:131], a[148:149], v[180:183]
    ds_read_b64_tr_b16 a[84:85], v218 offset:9216
    v_mfma_f32_16x16x16_bf16 v[160:163], a[132:133], a[150:151], v[160:163]
    ds_read_b64_tr_b16 a[86:87], v219 offset:9216
    v_mfma_f32_16x16x16_bf16 v[164:167], a[134:135], a[150:151], v[164:167]
    ds_read_b64_tr_b16 a[88:89], v218 offset:10240
    v_mfma_f32_16x16x16_bf16 v[168:171], a[136:137], a[150:151], v[168:171]
    ds_read_b64_tr_b16 a[90:91], v219 offset:10240
    v_mfma_f32_16x16x16_bf16 v[172:175], a[138:139], a[150:151], v[172:175]
    ds_read_b64_tr_b16 a[92:93], v218 offset:11264
    v_mfma_f32_16x16x16_bf16 v[176:179], a[140:141], a[150:151], v[176:179]
    ds_read_b64_tr_b16 a[94:95], v219 offset:11264
    v_mfma_f32_16x16x16_bf16 v[180:183], a[142:143], a[150:151], v[180:183]
    s_waitcnt lgkmcnt(15)
    v_mfma_f32_16x16x32_bf16 v[192:195], a[48:51], a[48:51], 0
    ds_read_b128 a[96:99], v220 offset:0
    v_mfma_f32_16x16x32_bf16 v[192:195], a[52:55], a[52:55], v[192:195]
    ds_read_b128 a[100:103], v220 offset:4096
    global_load_dwordx4 v[64:67], v208, s[14:15] offset:512 nt
    v_mfma_f32_16x16x32_bf16 v[192:195], a[56:59], a[56:59], v[192:195]
    ds_read_b128 a[104:107], v220 offset:8192
    s_waitcnt lgkmcnt(15)
    v_mfma_f32_16x16x32_bf16 v[192:195], a[60:63], a[60:63], v[192:195]
    ds_read_b128 a[108:111], v220 offset:12288
    global_load_dwordx4 v[40:43], v207, s[10:11] offset:512 nt
    v_mfma_f32_16x16x32_bf16 v[192:195], a[64:67], a[64:67], v[192:195]
    ds_read_b128 a[112:115], v220 offset:16384
    v_mfma_f32_16x16x32_bf16 v[192:195], a[68:71], a[68:71], v[192:195]
    ds_read_b128 a[116:119], v220 offset:20480
    global_load_dwordx4 v[44:47], v207, s[10:11] offset:1280 nt
    s_waitcnt lgkmcnt(12)
    v_mfma_f32_16x16x32_bf16 v[192:195], a[72:75], a[72:75], v[192:195]
    ds_read_b128 a[120:123], v220 offset:24576
    v_mfma_f32_16x16x32_bf16 v[192:195], a[76:79], a[76:79], v[192:195]
    ds_read_b128 a[124:127], v220 offset:28672
    global_load_dwordx4 v[48:51], v207, s[12:13] offset:512 nt
    v_mfma_f32_16x16x32_bf16 v[192:195], a[80:83], a[80:83], v[192:195]
    ds_read_b128 a[128:131], v220 offset:32768
    s_waitcnt lgkmcnt(9)
    v_mfma_f32_16x16x32_bf16 v[192:195], a[84:87], a[84:87], v[192:195]
    ds_read_b128 a[132:135], v220 offset:36864
    global_load_dwordx4 v[52:55], v207, s[12:13] offset:1280 nt
    v_mfma_f32_16x16x32_bf16 v[192:195], a[88:91], a[88:91], v[192:195]
    ds_read_b128 a[136:139], v220 offset:40960
    v_mfma_f32_16x16x32_bf16 v[192:195], a[92:95], a[92:95], v[192:195]
    ds_read_b128 a[140:143], v220 offset:45056
    v_mfma_f32_16x16x32_bf16 v[188:191], a[48:51], a[152:155], 0
    v_mfma_f32_16x16x32_bf16 v[188:191], a[52:55], a[152:155], v[188:191]
    v_mfma_f32_16x16x32_bf16 v[188:191], a[56:59], a[152:155], v[188:191]
    v_mfma_f32_16x16x32_bf16 v[188:191], a[60:63], a[152:155], v[188:191]
    v_mfma_f32_16x16x32_bf16 v[188:191], a[64:67], a[152:155], v[188:191]
    v_mfma_f32_16x16x32_bf16 v[188:191], a[68:71], a[152:155], v[188:191]
    v_mfma_f32_16x16x32_bf16 v[188:191], a[72:75], a[152:155], v[188:191]
    v_mfma_f32_16x16x32_bf16 v[188:191], a[76:79], a[152:155], v[188:191]
    v_cndmask_b32 v128, 0, v192, s[26:27]
    v_mfma_f32_16x16x32_bf16 v[188:191], a[80:83], a[152:155], v[188:191]
    v_cndmask_b32 v128, v128, v193, s[28:29]
    v_mfma_f32_16x16x32_bf16 v[188:191], a[84:87], a[152:155], v[188:191]
    v_cndmask_b32 v128, v128, v194, s[30:31]
    v_mfma_f32_16x16x32_bf16 v[188:191], a[88:91], a[152:155], v[188:191]
    v_cndmask_b32 v128, v128, v195, s[32:33]
    v_mfma_f32_16x16x32_bf16 v[188:191], a[92:95], a[152:155], v[188:191]
    v_mfma_f32_16x16x32_bf16 v[184:187], a[48:51], a[0:3], 0
    v_mfma_f32_16x16x4_f32 v[196:199], v128, v205, 0
    v_mfma_f32_16x16x32_bf16 v[184:187], a[52:55], a[4:7], v[184:187]
    v_mfma_f32_16x16x32_bf16 v[184:187], a[56:59], a[8:11], v[184:187]
    v_mfma_f32_16x16x32_bf16 v[184:187], a[60:63], a[12:15], v[184:187]
    v_mfma_f32_16x16x32_bf16 v[184:187], a[64:67], a[16:19], v[184:187]
    v_mfma_f32_16x16x32_bf16 v[184:187], a[68:71], a[20:23], v[184:187]
    v_mfma_f32_16x16x32_bf16 v[184:187], a[72:75], a[24:27], v[184:187]
    v_mul_f32 v188, s23, v188
    v_mfma_f32_16x16x32_bf16 v[184:187], a[76:79], a[28:31], v[184:187]
    v_mul_f32 v189, s23, v189
    v_mfma_f32_16x16x32_bf16 v[184:187], a[80:83], a[32:35], v[184:187]
    v_mul_f32 v190, s23, v190
    v_mfma_f32_16x16x32_bf16 v[184:187], a[84:87], a[36:39], v[184:187]
    v_mul_f32 v191, s23, v191
    v_mfma_f32_16x16x32_bf16 v[184:187], a[88:91], a[40:43], v[184:187]
    v_fma_f32 v128, -v188, v188, v206
    v_fma_f32 v129, -v189, v189, v206
    v_mfma_f32_16x16x32_bf16 v[184:187], a[92:95], a[44:47], v[184:187]
    v_fma_f32 v130, -v190, v190, v206
    v_fma_f32 v131, -v191, v191, v206
    v_fma_f32 v196, v196, s23, v128
    v_fma_f32 v197, v197, s23, v129
    v_fma_f32 v198, v198, s23, v130
    v_fma_f32 v199, v199, s23, v131
    v_rsq_f32 v196, v196
    v_rsq_f32 v197, v197
    v_rsq_f32 v198, v198
    v_rsq_f32 v199, v199
    v_pk_fma_f32 v[184:185], v[188:189], v[204:205], v[184:185] op_sel_hi:[1,0,1] neg_lo:[1,0,0] neg_hi:[1,0,0]
    v_pk_fma_f32 v[186:187], v[190:191], v[204:205], v[186:187] op_sel_hi:[1,0,1] neg_lo:[1,0,0] neg_hi:[1,0,0]
    v_pk_fma_f32 v[136:137], v[184:185], v[196:197], v[202:203] op_sel_hi:[1,1,0] neg_lo:[0,0,1] neg_hi:[0,0,1]
    v_pk_fma_f32 v[138:139], v[186:187], v[198:199], v[202:203] op_sel_hi:[1,1,0] neg_lo:[0,0,1] neg_hi:[0,0,1]
    v_max3_f32 v128, v136, v137, v138
    v_max_f32 v128, v128, v139
    v_cmp_lt_f32 vcc, s61, v128
    v_exp_f32 v136, v136
    v_exp_f32 v137, v137
    v_exp_f32 v138, v138
    v_exp_f32 v139, v139
    s_nop 0
    v_pk_mul_f32 v[132:133], v[136:137], v[196:197]
    v_pk_mul_f32 v[134:135], v[138:139], v[198:199]
    v_cvt_pk_bf16_f32 v200, v132, v133
    v_cvt_pk_bf16_f32 v201, v134, v135
    ds_write_b64 v213, v[200:201] offset:12288
    v_cndmask_b32 v128, 0, 1, vcc
    ds_write_b32 v254, v128 offset:10816
    v_add_f32 v136, v136, v137
    v_add_f32 v138, v138, v139
    v_lshlrev_b32 v132, 16, v200
    v_and_b32 v133, 0xffff0000, v200
    v_lshlrev_b32 v134, 16, v201
    v_and_b32 v135, 0xffff0000, v201
    v_add_f32 v140, v136, v138
    v_mul_f32 v141, v132, v188
    v_mul_f32 v132, v133, v189
    v_fmac_f32 v141, v134, v190
    v_fmac_f32 v132, v135, v191
    v_add_f32 v141, v141, v132
    s_waitcnt lgkmcnt(0)
    s_barrier
    ds_read_b128 v[128:131], v255 offset:10816
    ds_read_b64 a[144:145], v214 offset:12288
    ds_read_b64 a[146:147], v214 offset:12800
    ds_read_b64 a[148:149], v214 offset:13312
    ds_read_b64 a[150:151], v214 offset:13824
    s_waitcnt lgkmcnt(4)
    v_or3_b32 v128, v128, v129, v130
    v_or_b32 v128, v128, v131
    v_cmp_ne_u32 vcc, 0, v128
    s_cbranch_vccz BJ_31
    v_mul_f32 v136, v184, v196
    v_mul_f32 v137, v185, v197
    v_mul_f32 v138, v186, v198
    v_mul_f32 v139, v187, v199
    v_max3_f32 v128, v136, v137, v138
    v_max_f32 v128, v128, v139
    ds_max_f32 v215, v128
    s_waitcnt lgkmcnt(0)
    s_barrier
    ds_read_b32 v129, v215
    s_waitcnt lgkmcnt(0)
    v_sub_f32 v130, v202, v129
    v_sub_f32 v136, v136, v129
    v_sub_f32 v137, v137, v129
    v_sub_f32 v138, v138, v129
    v_sub_f32 v139, v139, v129
    v_exp_f32 v130, v130
    v_mov_b32 v202, v129
    v_exp_f32 v136, v136
    v_exp_f32 v137, v137
    v_exp_f32 v138, v138
    v_exp_f32 v139, v139
    s_nop 0
    v_pk_mul_f32 v[132:133], v[136:137], v[196:197]
    v_pk_mul_f32 v[134:135], v[138:139], v[198:199]
    v_cvt_pk_bf16_f32 v200, v132, v133
    v_cvt_pk_bf16_f32 v201, v134, v135
    ds_write_b64 v213, v[200:201] offset:12288
    v_mul_f32 v203, v203, v130
    v_mul_f32 v221, v221, v130
    v_pk_mul_f32 v[160:161], v[160:161], v[130:131] op_sel_hi:[1,0]
    v_pk_mul_f32 v[162:163], v[162:163], v[130:131] op_sel_hi:[1,0]
    v_pk_mul_f32 v[164:165], v[164:165], v[130:131] op_sel_hi:[1,0]
    v_pk_mul_f32 v[166:167], v[166:167], v[130:131] op_sel_hi:[1,0]
    v_pk_mul_f32 v[168:169], v[168:169], v[130:131] op_sel_hi:[1,0]
    v_pk_mul_f32 v[170:171], v[170:171], v[130:131] op_sel_hi:[1,0]
    v_pk_mul_f32 v[172:173], v[172:173], v[130:131] op_sel_hi:[1,0]
    v_pk_mul_f32 v[174:175], v[174:175], v[130:131] op_sel_hi:[1,0]
    v_pk_mul_f32 v[176:177], v[176:177], v[130:131] op_sel_hi:[1,0]
    v_pk_mul_f32 v[178:179], v[178:179], v[130:131] op_sel_hi:[1,0]
    v_pk_mul_f32 v[180:181], v[180:181], v[130:131] op_sel_hi:[1,0]
    v_pk_mul_f32 v[182:183], v[182:183], v[130:131] op_sel_hi:[1,0]
    v_add_f32 v136, v136, v137
    v_add_f32 v138, v138, v139
    v_lshlrev_b32 v132, 16, v200
    v_and_b32 v133, 0xffff0000, v200
    v_lshlrev_b32 v134, 16, v201
    v_and_b32 v135, 0xffff0000, v201
    v_add_f32 v140, v136, v138
    v_mul_f32 v141, v132, v188
    v_mul_f32 v132, v133, v189
    v_fmac_f32 v141, v134, v190
    v_fmac_f32 v132, v135, v191
    v_add_f32 v141, v141, v132
    s_waitcnt lgkmcnt(0)
    s_barrier
    ds_read_b64 a[144:145], v214 offset:12288
    ds_read_b64 a[146:147], v214 offset:12800
    ds_read_b64 a[148:149], v214 offset:13312
    ds_read_b64 a[150:151], v214 offset:13824
BJ_31:
    v_add_f32 v203, v203, v140
    v_add_f32 v221, v221, v141
    v_add_u32 v217, 98304, v209
    s_waitcnt lgkmcnt(0)
    s_waitcnt vmcnt(25)
    v_lshlrev_b32 v136, 16, v116
    v_and_b32 v137, 0xffff0000, v116
    v_dot2_f32_bf16 v128, v68, s20, v136
    v_dot2_f32_bf16 v129, v72, s20, v136
    v_dot2_f32_bf16 v130, v76, s20, v136
    v_dot2_f32_bf16 v131, v80, s20, v136
    v_dot2_f32_bf16 v132, v68, s21, v137
    v_dot2_f32_bf16 v133, v72, s21, v137
    v_dot2_f32_bf16 v134, v76, s21, v137
    v_dot2_f32_bf16 v135, v80, s21, v137
    v_lshlrev_b32 v146, 16, v117
    v_and_b32 v147, 0xffff0000, v117
    v_dot2_f32_bf16 v138, v69, s20, v146
    v_cvt_pk_bf16_f32 v152, v128, v129
    v_dot2_f32_bf16 v139, v73, s20, v146
    v_cvt_pk_bf16_f32 v153, v130, v131
    v_dot2_f32_bf16 v140, v77, s20, v146
    v_cvt_pk_bf16_f32 v154, v132, v133
    v_dot2_f32_bf16 v141, v81, s20, v146
    v_cvt_pk_bf16_f32 v155, v134, v135
    v_mfma_f32_16x16x16_bf16 v[160:163], a[96:97], a[144:145], v[160:163]
    v_mfma_f32_16x16x16_bf16 v[164:167], a[98:99], a[144:145], v[164:167]
    ds_write_b128 v217, v[152:155] offset:0
    v_dot2_f32_bf16 v142, v69, s21, v147
    v_dot2_f32_bf16 v143, v73, s21, v147
    v_dot2_f32_bf16 v144, v77, s21, v147
    v_dot2_f32_bf16 v145, v81, s21, v147
    v_lshlrev_b32 v136, 16, v118
    v_and_b32 v137, 0xffff0000, v118
    v_dot2_f32_bf16 v128, v70, s20, v136
    v_cvt_pk_bf16_f32 v156, v138, v139
    v_dot2_f32_bf16 v129, v74, s20, v136
    v_cvt_pk_bf16_f32 v157, v140, v141
    v_dot2_f32_bf16 v130, v78, s20, v136
    v_cvt_pk_bf16_f32 v158, v142, v143
    v_dot2_f32_bf16 v131, v82, s20, v136
    v_cvt_pk_bf16_f32 v159, v144, v145
    v_mfma_f32_16x16x16_bf16 v[168:171], a[100:101], a[144:145], v[168:171]
    v_mfma_f32_16x16x16_bf16 v[172:175], a[102:103], a[144:145], v[172:175]
    ds_write_b128 v217, v[156:159] offset:1024
    v_dot2_f32_bf16 v132, v70, s21, v137
    v_dot2_f32_bf16 v133, v74, s21, v137
    v_dot2_f32_bf16 v134, v78, s21, v137
    v_dot2_f32_bf16 v135, v82, s21, v137
    v_lshlrev_b32 v146, 16, v119
    v_and_b32 v147, 0xffff0000, v119
    v_dot2_f32_bf16 v138, v71, s20, v146
    v_cvt_pk_bf16_f32 v152, v128, v129
    v_dot2_f32_bf16 v139, v75, s20, v146
    v_cvt_pk_bf16_f32 v153, v130, v131
    v_dot2_f32_bf16 v140, v79, s20, v146
    v_cvt_pk_bf16_f32 v154, v132, v133
    v_dot2_f32_bf16 v141, v83, s20, v146
    v_cvt_pk_bf16_f32 v155, v134, v135
    v_mfma_f32_16x16x16_bf16 v[176:179], a[104:105], a[144:145], v[176:179]
    v_mfma_f32_16x16x16_bf16 v[180:183], a[106:107], a[144:145], v[180:183]
    ds_write_b128 v217, v[152:155] offset:2048
    v_dot2_f32_bf16 v142, v71, s21, v147
    v_dot2_f32_bf16 v143, v75, s21, v147
    v_dot2_f32_bf16 v144, v79, s21, v147
    v_dot2_f32_bf16 v145, v83, s21, v147
    s_waitcnt vmcnt(20)
    v_lshlrev_b32 v136, 16, v120
    v_and_b32 v137, 0xffff0000, v120
    v_dot2_f32_bf16 v128, v84, s20, v136
    v_cvt_pk_bf16_f32 v156, v138, v139
    v_dot2_f32_bf16 v129, v88, s20, v136
    v_cvt_pk_bf16_f32 v157, v140, v141
    v_dot2_f32_bf16 v130, v92, s20, v136
    v_cvt_pk_bf16_f32 v158, v142, v143
    v_dot2_f32_bf16 v131, v96, s20, v136
    v_cvt_pk_bf16_f32 v159, v144, v145
    v_mfma_f32_16x16x16_bf16 v[160:163], a[108:109], a[146:147], v[160:163]
    v_mfma_f32_16x16x16_bf16 v[164:167], a[110:111], a[146:147], v[164:167]
    ds_write_b128 v217, v[156:159] offset:3072
    v_dot2_f32_bf16 v132, v84, s21, v137
    v_dot2_f32_bf16 v133, v88, s21, v137
    v_dot2_f32_bf16 v134, v92, s21, v137
    v_dot2_f32_bf16 v135, v96, s21, v137
    v_lshlrev_b32 v146, 16, v121
    v_and_b32 v147, 0xffff0000, v121
    v_dot2_f32_bf16 v138, v85, s20, v146
    v_cvt_pk_bf16_f32 v152, v128, v129
    v_dot2_f32_bf16 v139, v89, s20, v146
    v_cvt_pk_bf16_f32 v153, v130, v131
    v_dot2_f32_bf16 v140, v93, s20, v146
    v_cvt_pk_bf16_f32 v154, v132, v133
    v_dot2_f32_bf16 v141, v97, s20, v146
    v_cvt_pk_bf16_f32 v155, v134, v135
    v_mfma_f32_16x16x16_bf16 v[168:171], a[112:113], a[146:147], v[168:171]
    v_mfma_f32_16x16x16_bf16 v[172:175], a[114:115], a[146:147], v[172:175]
    ds_write_b128 v217, v[152:155] offset:4096
    v_dot2_f32_bf16 v142, v85, s21, v147
    v_dot2_f32_bf16 v143, v89, s21, v147
    v_dot2_f32_bf16 v144, v93, s21, v147
    v_dot2_f32_bf16 v145, v97, s21, v147
    v_lshlrev_b32 v136, 16, v122
    v_and_b32 v137, 0xffff0000, v122
    v_dot2_f32_bf16 v128, v86, s20, v136
    v_cvt_pk_bf16_f32 v156, v138, v139
    v_dot2_f32_bf16 v129, v90, s20, v136
    v_cvt_pk_bf16_f32 v157, v140, v141
    v_dot2_f32_bf16 v130, v94, s20, v136
    v_cvt_pk_bf16_f32 v158, v142, v143
    v_dot2_f32_bf16 v131, v98, s20, v136
    v_cvt_pk_bf16_f32 v159, v144, v145
    v_mfma_f32_16x16x16_bf16 v[176:179], a[116:117], a[146:147], v[176:179]
    v_mfma_f32_16x16x16_bf16 v[180:183], a[118:119], a[146:147], v[180:183]
    ds_write_b128 v217, v[156:159] offset:5120
    s_mul_hi_u32 s34, s19, 89478486
    s_mul_i32 s35, s34, 48
    s_sub_u32 s35, s19, s35
    s_mul_i32 s34, s34, 589824
    s_mul_i32 s35, s35, 6144
    s_add_u32 s34, s34, s35
    s_add_u32 s44, s4, s34
    s_addc_u32 s45, s5, 0
    s_add_u32 s46, s44, 294912
    s_addc_u32 s47, s45, 0
    s_mul_i32 s34, s19, 3072
    s_add_u32 s48, s6, s34
    s_addc_u32 s49, s7, 0
    s_add_u32 s19, s19, 4
    global_load_dwordx4 v[116:119], v208, s[48:49] offset:0 nt
    v_dot2_f32_bf16 v132, v86, s21, v137
    v_dot2_f32_bf16 v133, v90, s21, v137
    v_dot2_f32_bf16 v134, v94, s21, v137
    v_dot2_f32_bf16 v135, v98, s21, v137
    v_lshlrev_b32 v146, 16, v123
    v_and_b32 v147, 0xffff0000, v123
    v_dot2_f32_bf16 v138, v87, s20, v146
    v_cvt_pk_bf16_f32 v152, v128, v129
    v_dot2_f32_bf16 v139, v91, s20, v146
    v_cvt_pk_bf16_f32 v153, v130, v131
    v_dot2_f32_bf16 v140, v95, s20, v146
    v_cvt_pk_bf16_f32 v154, v132, v133
    v_dot2_f32_bf16 v141, v99, s20, v146
    v_cvt_pk_bf16_f32 v155, v134, v135
    v_mfma_f32_16x16x16_bf16 v[160:163], a[120:121], a[148:149], v[160:163]
    v_mfma_f32_16x16x16_bf16 v[164:167], a[122:123], a[148:149], v[164:167]
    ds_write_b128 v217, v[152:155] offset:6144
    global_load_dwordx4 v[68:71], v207, s[44:45] offset:0 nt
    v_dot2_f32_bf16 v142, v87, s21, v147
    v_dot2_f32_bf16 v143, v91, s21, v147
    v_dot2_f32_bf16 v144, v95, s21, v147
    v_dot2_f32_bf16 v145, v99, s21, v147
    s_waitcnt vmcnt(17)
    v_lshlrev_b32 v136, 16, v124
    v_and_b32 v137, 0xffff0000, v124
    v_dot2_f32_bf16 v128, v100, s20, v136
    v_cvt_pk_bf16_f32 v156, v138, v139
    v_dot2_f32_bf16 v129, v104, s20, v136
    v_cvt_pk_bf16_f32 v157, v140, v141
    v_dot2_f32_bf16 v130, v108, s20, v136
    v_cvt_pk_bf16_f32 v158, v142, v143
    v_dot2_f32_bf16 v131, v112, s20, v136
    v_cvt_pk_bf16_f32 v159, v144, v145
    v_mfma_f32_16x16x16_bf16 v[168:171], a[124:125], a[148:149], v[168:171]
    v_mfma_f32_16x16x16_bf16 v[172:175], a[126:127], a[148:149], v[172:175]
    ds_write_b128 v217, v[156:159] offset:7168
    global_load_dwordx4 v[72:75], v207, s[44:45] offset:768 nt
    v_dot2_f32_bf16 v132, v100, s21, v137
    v_dot2_f32_bf16 v133, v104, s21, v137
    v_dot2_f32_bf16 v134, v108, s21, v137
    v_dot2_f32_bf16 v135, v112, s21, v137
    v_lshlrev_b32 v146, 16, v125
    v_and_b32 v147, 0xffff0000, v125
    v_dot2_f32_bf16 v138, v101, s20, v146
    v_cvt_pk_bf16_f32 v152, v128, v129
    v_dot2_f32_bf16 v139, v105, s20, v146
    v_cvt_pk_bf16_f32 v153, v130, v131
    v_dot2_f32_bf16 v140, v109, s20, v146
    v_cvt_pk_bf16_f32 v154, v132, v133
    v_dot2_f32_bf16 v141, v113, s20, v146
    v_cvt_pk_bf16_f32 v155, v134, v135
    v_mfma_f32_16x16x16_bf16 v[176:179], a[128:129], a[148:149], v[176:179]
    v_mfma_f32_16x16x16_bf16 v[180:183], a[130:131], a[148:149], v[180:183]
    ds_write_b128 v217, v[152:155] offset:8192
    global_load_dwordx4 v[76:79], v207, s[46:47] offset:0 nt
    v_dot2_f32_bf16 v142, v101, s21, v147
    v_dot2_f32_bf16 v143, v105, s21, v147
    v_dot2_f32_bf16 v144, v109, s21, v147
    v_dot2_f32_bf16 v145, v113, s21, v147
    v_lshlrev_b32 v136, 16, v126
    v_and_b32 v137, 0xffff0000, v126
    v_dot2_f32_bf16 v128, v102, s20, v136
    v_cvt_pk_bf16_f32 v156, v138, v139
    v_dot2_f32_bf16 v129, v106, s20, v136
    v_cvt_pk_bf16_f32 v157, v140, v141
    v_dot2_f32_bf16 v130, v110, s20, v136
    v_cvt_pk_bf16_f32 v158, v142, v143
    v_dot2_f32_bf16 v131, v114, s20, v136
    v_cvt_pk_bf16_f32 v159, v144, v145
    v_mfma_f32_16x16x16_bf16 v[160:163], a[132:133], a[150:151], v[160:163]
    v_mfma_f32_16x16x16_bf16 v[164:167], a[134:135], a[150:151], v[164:167]
    ds_write_b128 v217, v[156:159] offset:9216
    global_load_dwordx4 v[80:83], v207, s[46:47] offset:768 nt
    v_dot2_f32_bf16 v132, v102, s21, v137
    v_dot2_f32_bf16 v133, v106, s21, v137
    v_dot2_f32_bf16 v134, v110, s21, v137
    v_dot2_f32_bf16 v135, v114, s21, v137
    v_lshlrev_b32 v146, 16, v127
    v_and_b32 v147, 0xffff0000, v127
    v_dot2_f32_bf16 v138, v103, s20, v146
    v_cvt_pk_bf16_f32 v152, v128, v129
    v_dot2_f32_bf16 v139, v107, s20, v146
    v_cvt_pk_bf16_f32 v153, v130, v131
    v_dot2_f32_bf16 v140, v111, s20, v146
    v_cvt_pk_bf16_f32 v154, v132, v133
    v_dot2_f32_bf16 v141, v115, s20, v146
    v_cvt_pk_bf16_f32 v155, v134, v135
    v_mfma_f32_16x16x16_bf16 v[168:171], a[136:137], a[150:151], v[168:171]
    v_mfma_f32_16x16x16_bf16 v[172:175], a[138:139], a[150:151], v[172:175]
    ds_write_b128 v217, v[152:155] offset:10240
    v_dot2_f32_bf16 v142, v103, s21, v147
    v_dot2_f32_bf16 v143, v107, s21, v147
    v_dot2_f32_bf16 v144, v111, s21, v147
    v_dot2_f32_bf16 v145, v115, s21, v147
    s_nop 0
    v_cvt_pk_bf16_f32 v156, v138, v139
    v_cvt_pk_bf16_f32 v157, v140, v141
    v_cvt_pk_bf16_f32 v158, v142, v143
    v_cvt_pk_bf16_f32 v159, v144, v145
    v_mfma_f32_16x16x16_bf16 v[176:179], a[140:141], a[150:151], v[176:179]
    v_mfma_f32_16x16x16_bf16 v[180:183], a[142:143], a[150:151], v[180:183]
    ds_write_b128 v217, v[156:159] offset:11264
    v_add_u32 v218, 98304, v210
    v_add_u32 v219, 98304, v211
    v_add_u32 v220, 98304, v212
    s_waitcnt lgkmcnt(0)
    s_barrier
    ds_read_b64_tr_b16 a[48:49], v218 offset:0
    ds_read_b64_tr_b16 a[50:51], v219 offset:0
    ds_read_b64_tr_b16 a[52:53], v218 offset:1024
    ds_read_b64_tr_b16 a[54:55], v219 offset:1024
    ds_read_b64_tr_b16 a[56:57], v218 offset:2048
    ds_read_b64_tr_b16 a[58:59], v219 offset:2048
    ds_read_b64_tr_b16 a[60:61], v218 offset:3072
    ds_read_b64_tr_b16 a[62:63], v219 offset:3072
    ds_read_b64_tr_b16 a[64:65], v218 offset:4096
    ds_read_b64_tr_b16 a[66:67], v219 offset:4096
    ds_read_b64_tr_b16 a[68:69], v218 offset:5120
    ds_read_b64_tr_b16 a[70:71], v219 offset:5120
    ds_read_b64_tr_b16 a[72:73], v218 offset:6144
    ds_read_b64_tr_b16 a[74:75], v219 offset:6144
    ds_read_b64_tr_b16 a[76:77], v218 offset:7168
    ds_read_b64_tr_b16 a[78:79], v219 offset:7168
    ds_read_b64_tr_b16 a[80:81], v218 offset:8192
    ds_read_b64_tr_b16 a[82:83], v219 offset:8192
    ds_read_b64_tr_b16 a[84:85], v218 offset:9216
    ds_read_b64_tr_b16 a[86:87], v219 offset:9216
    ds_read_b64_tr_b16 a[88:89], v218 offset:10240
    ds_read_b64_tr_b16 a[90:91], v219 offset:10240
    ds_read_b64_tr_b16 a[92:93], v218 offset:11264
    ds_read_b64_tr_b16 a[94:95], v219 offset:11264
    s_waitcnt lgkmcnt(15)
    v_mfma_f32_16x16x32_bf16 v[192:195], a[48:51], a[48:51], 0
    ds_read_b128 a[96:99], v220 offset:0
    v_mfma_f32_16x16x32_bf16 v[192:195], a[52:55], a[52:55], v[192:195]
    ds_read_b128 a[100:103], v220 offset:4096
    global_load_dwordx4 v[120:123], v208, s[48:49] offset:256 nt
    v_mfma_f32_16x16x32_bf16 v[192:195], a[56:59], a[56:59], v[192:195]
    ds_read_b128 a[104:107], v220 offset:8192
    s_waitcnt lgkmcnt(15)
    v_mfma_f32_16x16x32_bf16 v[192:195], a[60:63], a[60:63], v[192:195]
    ds_read_b128 a[108:111], v220 offset:12288
    global_load_dwordx4 v[84:87], v207, s[44:45] offset:256 nt
    v_mfma_f32_16x16x32_bf16 v[192:195], a[64:67], a[64:67], v[192:195]
    ds_read_b128 a[112:115], v220 offset:16384
    v_mfma_f32_16x16x32_bf16 v[192:195], a[68:71], a[68:71], v[192:195]
    ds_read_b128 a[116:119], v220 offset:20480
    global_load_dwordx4 v[88:91], v207, s[44:45] offset:1024 nt
    s_waitcnt lgkmcnt(12)
    v_mfma_f32_16x16x32_bf16 v[192:195], a[72:75], a[72:75], v[192:195]
    ds_read_b128 a[120:123], v220 offset:24576
    v_mfma_f32_16x16x32_bf16 v[192:195], a[76:79], a[76:79], v[192:195]
    ds_read_b128 a[124:127], v220 offset:28672
    global_load_dwordx4 v[92:95], v207, s[46:47] offset:256 nt
    v_mfma_f32_16x16x32_bf16 v[192:195], a[80:83], a[80:83], v[192:195]
    ds_read_b128 a[128:131], v220 offset:32768
    s_waitcnt lgkmcnt(9)
    v_mfma_f32_16x16x32_bf16 v[192:195], a[84:87], a[84:87], v[192:195]
    ds_read_b128 a[132:135], v220 offset:36864
    global_load_dwordx4 v[96:99], v207, s[46:47] offset:1024 nt
    v_mfma_f32_16x16x32_bf16 v[192:195], a[88:91], a[88:91], v[192:195]
    ds_read_b128 a[136:139], v220 offset:40960
    v_mfma_f32_16x16x32_bf16 v[192:195], a[92:95], a[92:95], v[192:195]
    ds_read_b128 a[140:143], v220 offset:45056
    v_mfma_f32_16x16x32_bf16 v[188:191], a[48:51], a[152:155], 0
    v_mfma_f32_16x16x32_bf16 v[188:191], a[52:55], a[152:155], v[188:191]
    v_mfma_f32_16x16x32_bf16 v[188:191], a[56:59], a[152:155], v[188:191]
    v_mfma_f32_16x16x32_bf16 v[188:191], a[60:63], a[152:155], v[188:191]
    v_mfma_f32_16x16x32_bf16 v[188:191], a[64:67], a[152:155], v[188:191]
    v_mfma_f32_16x16x32_bf16 v[188:191], a[68:71], a[152:155], v[188:191]
    v_mfma_f32_16x16x32_bf16 v[188:191], a[72:75], a[152:155], v[188:191]
    v_mfma_f32_16x16x32_bf16 v[188:191], a[76:79], a[152:155], v[188:191]
    v_cndmask_b32 v128, 0, v192, s[26:27]
    v_mfma_f32_16x16x32_bf16 v[188:191], a[80:83], a[152:155], v[188:191]
    v_cndmask_b32 v128, v128, v193, s[28:29]
    v_mfma_f32_16x16x32_bf16 v[188:191], a[84:87], a[152:155], v[188:191]
    v_cndmask_b32 v128, v128, v194, s[30:31]
    v_mfma_f32_16x16x32_bf16 v[188:191], a[88:91], a[152:155], v[188:191]
    v_cndmask_b32 v128, v128, v195, s[32:33]
    v_mfma_f32_16x16x32_bf16 v[188:191], a[92:95], a[152:155], v[188:191]
    v_mfma_f32_16x16x32_bf16 v[184:187], a[48:51], a[0:3], 0
    v_mfma_f32_16x16x4_f32 v[196:199], v128, v205, 0
    v_mfma_f32_16x16x32_bf16 v[184:187], a[52:55], a[4:7], v[184:187]
    v_mfma_f32_16x16x32_bf16 v[184:187], a[56:59], a[8:11], v[184:187]
    v_mfma_f32_16x16x32_bf16 v[184:187], a[60:63], a[12:15], v[184:187]
    v_mfma_f32_16x16x32_bf16 v[184:187], a[64:67], a[16:19], v[184:187]
    v_mfma_f32_16x16x32_bf16 v[184:187], a[68:71], a[20:23], v[184:187]
    v_mfma_f32_16x16x32_bf16 v[184:187], a[72:75], a[24:27], v[184:187]
    v_mul_f32 v188, s23, v188
    v_mfma_f32_16x16x32_bf16 v[184:187], a[76:79], a[28:31], v[184:187]
    v_mul_f32 v189, s23, v189
    v_mfma_f32_16x16x32_bf16 v[184:187], a[80:83], a[32:35], v[184:187]
    v_mul_f32 v190, s23, v190
    v_mfma_f32_16x16x32_bf16 v[184:187], a[84:87], a[36:39], v[184:187]
    v_mul_f32 v191, s23, v191
    v_mfma_f32_16x16x32_bf16 v[184:187], a[88:91], a[40:43], v[184:187]
    v_fma_f32 v128, -v188, v188, v206
    v_fma_f32 v129, -v189, v189, v206
    v_mfma_f32_16x16x32_bf16 v[184:187], a[92:95], a[44:47], v[184:187]
    v_fma_f32 v130, -v190, v190, v206
    v_fma_f32 v131, -v191, v191, v206
    v_fma_f32 v196, v196, s23, v128
    v_fma_f32 v197, v197, s23, v129
    v_fma_f32 v198, v198, s23, v130
    v_fma_f32 v199, v199, s23, v131
    v_rsq_f32 v196, v196
    v_rsq_f32 v197, v197
    v_rsq_f32 v198, v198
    v_rsq_f32 v199, v199
    v_pk_fma_f32 v[184:185], v[188:189], v[204:205], v[184:185] op_sel_hi:[1,0,1] neg_lo:[1,0,0] neg_hi:[1,0,0]
    v_pk_fma_f32 v[186:187], v[190:191], v[204:205], v[186:187] op_sel_hi:[1,0,1] neg_lo:[1,0,0] neg_hi:[1,0,0]
    v_pk_fma_f32 v[136:137], v[184:185], v[196:197], v[202:203] op_sel_hi:[1,1,0] neg_lo:[0,0,1] neg_hi:[0,0,1]
    v_pk_fma_f32 v[138:139], v[186:187], v[198:199], v[202:203] op_sel_hi:[1,1,0] neg_lo:[0,0,1] neg_hi:[0,0,1]
    v_max3_f32 v128, v136, v137, v138
    v_max_f32 v128, v128, v139
    v_cmp_lt_f32 vcc, s61, v128
    v_exp_f32 v136, v136
    v_exp_f32 v137, v137
    v_exp_f32 v138, v138
    v_exp_f32 v139, v139
    s_nop 0
    v_pk_mul_f32 v[132:133], v[136:137], v[196:197]
    v_pk_mul_f32 v[134:135], v[138:139], v[198:199]
    v_cvt_pk_bf16_f32 v200, v132, v133
    v_cvt_pk_bf16_f32 v201, v134, v135
    ds_write_b64 v213, v[200:201] offset:0
    v_cndmask_b32 v128, 0, 1, vcc
    ds_write_b32 v254, v128 offset:0
    v_add_f32 v136, v136, v137
    v_add_f32 v138, v138, v139
    v_lshlrev_b32 v132, 16, v200
    v_and_b32 v133, 0xffff0000, v200
    v_lshlrev_b32 v134, 16, v201
    v_and_b32 v135, 0xffff0000, v201
    v_add_f32 v140, v136, v138
    v_mul_f32 v141, v132, v188
    v_mul_f32 v132, v133, v189
    v_fmac_f32 v141, v134, v190
    v_fmac_f32 v132, v135, v191
    v_add_f32 v141, v141, v132
    s_waitcnt lgkmcnt(0)
    s_barrier
    ds_read_b128 v[128:131], v255 offset:0
    ds_read_b64 a[144:145], v214 offset:0
    ds_read_b64 a[146:147], v214 offset:512
    ds_read_b64 a[148:149], v214 offset:1024
    ds_read_b64 a[150:151], v214 offset:1536
    s_waitcnt lgkmcnt(4)
    v_or3_b32 v128, v128, v129, v130
    v_or_b32 v128, v128, v131
    v_cmp_ne_u32 vcc, 0, v128
    s_cbranch_vccz BJ_33
    v_mul_f32 v136, v184, v196
    v_mul_f32 v137, v185, v197
    v_mul_f32 v138, v186, v198
    v_mul_f32 v139, v187, v199
    v_max3_f32 v128, v136, v137, v138
    v_max_f32 v128, v128, v139
    ds_max_f32 v215, v128
    s_waitcnt lgkmcnt(0)
    s_barrier
    ds_read_b32 v129, v215
    s_waitcnt lgkmcnt(0)
    v_sub_f32 v130, v202, v129
    v_sub_f32 v136, v136, v129
    v_sub_f32 v137, v137, v129
    v_sub_f32 v138, v138, v129
    v_sub_f32 v139, v139, v129
    v_exp_f32 v130, v130
    v_mov_b32 v202, v129
    v_exp_f32 v136, v136
    v_exp_f32 v137, v137
    v_exp_f32 v138, v138
    v_exp_f32 v139, v139
    s_nop 0
    v_pk_mul_f32 v[132:133], v[136:137], v[196:197]
    v_pk_mul_f32 v[134:135], v[138:139], v[198:199]
    v_cvt_pk_bf16_f32 v200, v132, v133
    v_cvt_pk_bf16_f32 v201, v134, v135
    ds_write_b64 v213, v[200:201] offset:0
    v_mul_f32 v203, v203, v130
    v_mul_f32 v221, v221, v130
    v_pk_mul_f32 v[160:161], v[160:161], v[130:131] op_sel_hi:[1,0]
    v_pk_mul_f32 v[162:163], v[162:163], v[130:131] op_sel_hi:[1,0]
    v_pk_mul_f32 v[164:165], v[164:165], v[130:131] op_sel_hi:[1,0]
    v_pk_mul_f32 v[166:167], v[166:167], v[130:131] op_sel_hi:[1,0]
    v_pk_mul_f32 v[168:169], v[168:169], v[130:131] op_sel_hi:[1,0]
    v_pk_mul_f32 v[170:171], v[170:171], v[130:131] op_sel_hi:[1,0]
    v_pk_mul_f32 v[172:173], v[172:173], v[130:131] op_sel_hi:[1,0]
    v_pk_mul_f32 v[174:175], v[174:175], v[130:131] op_sel_hi:[1,0]
    v_pk_mul_f32 v[176:177], v[176:177], v[130:131] op_sel_hi:[1,0]
    v_pk_mul_f32 v[178:179], v[178:179], v[130:131] op_sel_hi:[1,0]
    v_pk_mul_f32 v[180:181], v[180:181], v[130:131] op_sel_hi:[1,0]
    v_pk_mul_f32 v[182:183], v[182:183], v[130:131] op_sel_hi:[1,0]
    v_add_f32 v136, v136, v137
    v_add_f32 v138, v138, v139
    v_lshlrev_b32 v132, 16, v200
    v_and_b32 v133, 0xffff0000, v200
    v_lshlrev_b32 v134, 16, v201
    v_and_b32 v135, 0xffff0000, v201
    v_add_f32 v140, v136, v138
    v_mul_f32 v141, v132, v188
    v_mul_f32 v132, v133, v189
    v_fmac_f32 v141, v134, v190
    v_fmac_f32 v132, v135, v191
    v_add_f32 v141, v141, v132
    s_waitcnt lgkmcnt(0)
    s_barrier
    ds_read_b64 a[144:145], v214 offset:0
    ds_read_b64 a[146:147], v214 offset:512
    ds_read_b64 a[148:149], v214 offset:1024
    ds_read_b64 a[150:151], v214 offset:1536
BJ_33:
    v_add_f32 v203, v203, v140
    v_add_f32 v221, v221, v141
    v_add_u32 v217, 0, v209
    s_waitcnt lgkmcnt(0)
    s_waitcnt vmcnt(20)
    v_lshlrev_b32 v136, 16, v56
    v_and_b32 v137, 0xffff0000, v56
    v_dot2_f32_bf16 v128, v8, s20, v136
    v_dot2_f32_bf16 v129, v12, s20, v136
    v_dot2_f32_bf16 v130, v16, s20, v136
    v_dot2_f32_bf16 v131, v20, s20, v136
    global_load_dwordx4 v[124:127], v208, s[48:49] offset:512 nt
    v_dot2_f32_bf16 v132, v8, s21, v137
    v_dot2_f32_bf16 v133, v12, s21, v137
    v_dot2_f32_bf16 v134, v16, s21, v137
    v_dot2_f32_bf16 v135, v20, s21, v137
    v_lshlrev_b32 v146, 16, v57
    v_and_b32 v147, 0xffff0000, v57
    v_dot2_f32_bf16 v138, v9, s20, v146
    v_cvt_pk_bf16_f32 v152, v128, v129
    v_dot2_f32_bf16 v139, v13, s20, v146
    v_cvt_pk_bf16_f32 v153, v130, v131
    v_dot2_f32_bf16 v140, v17, s20, v146
    v_cvt_pk_bf16_f32 v154, v132, v133
    v_dot2_f32_bf16 v141, v21, s20, v146
    v_cvt_pk_bf16_f32 v155, v134, v135
    v_mfma_f32_16x16x16_bf16 v[160:163], a[96:97], a[144:145], v[160:163]
    v_mfma_f32_16x16x16_bf16 v[164:167], a[98:99], a[144:145], v[164:167]
    ds_write_b128 v217, v[152:155] offset:0
    global_load_dwordx4 v[100:103], v207, s[44:45] offset:512 nt
    v_dot2_f32_bf16 v142, v9, s21, v147
    v_dot2_f32_bf16 v143, v13, s21, v147
    v_dot2_f32_bf16 v144, v17, s21, v147
    v_dot2_f32_bf16 v145, v21, s21, v147
    v_lshlrev_b32 v136, 16, v58
    v_and_b32 v137, 0xffff0000, v58
    v_dot2_f32_bf16 v128, v10, s20, v136
    v_cvt_pk_bf16_f32 v156, v138, v139
    v_dot2_f32_bf16 v129, v14, s20, v136
    v_cvt_pk_bf16_f32 v157, v140, v141
    v_dot2_f32_bf16 v130, v18, s20, v136
    v_cvt_pk_bf16_f32 v158, v142, v143
    v_dot2_f32_bf16 v131, v22, s20, v136
    v_cvt_pk_bf16_f32 v159, v144, v145
    v_mfma_f32_16x16x16_bf16 v[168:171], a[100:101], a[144:145], v[168:171]
    v_mfma_f32_16x16x16_bf16 v[172:175], a[102:103], a[144:145], v[172:175]
    ds_write_b128 v217, v[156:159] offset:1024
    global_load_dwordx4 v[104:107], v207, s[44:45] offset:1280 nt
    v_dot2_f32_bf16 v132, v10, s21, v137
    v_dot2_f32_bf16 v133, v14, s21, v137
    v_dot2_f32_bf16 v134, v18, s21, v137
    v_dot2_f32_bf16 v135, v22, s21, v137
    v_lshlrev_b32 v146, 16, v59
    v_and_b32 v147, 0xffff0000, v59
    v_dot2_f32_bf16 v138, v11, s20, v146
    v_cvt_pk_bf16_f32 v152, v128, v129
    v_dot2_f32_bf16 v139, v15, s20, v146
    v_cvt_pk_bf16_f32 v153, v130, v131
    v_dot2_f32_bf16 v140, v19, s20, v146
    v_cvt_pk_bf16_f32 v154, v132, v133
    v_dot2_f32_bf16 v141, v23, s20, v146
    v_cvt_pk_bf16_f32 v155, v134, v135
    v_mfma_f32_16x16x16_bf16 v[176:179], a[104:105], a[144:145], v[176:179]
    v_mfma_f32_16x16x16_bf16 v[180:183], a[106:107], a[144:145], v[180:183]
    ds_write_b128 v217, v[152:155] offset:2048
    global_load_dwordx4 v[108:111], v207, s[46:47] offset:512 nt
    v_dot2_f32_bf16 v142, v11, s21, v147
    v_dot2_f32_bf16 v143, v15, s21, v147
    v_dot2_f32_bf16 v144, v19, s21, v147
    v_dot2_f32_bf16 v145, v23, s21, v147
    s_waitcnt vmcnt(19)
    v_lshlrev_b32 v136, 16, v60
    v_and_b32 v137, 0xffff0000, v60
    v_dot2_f32_bf16 v128, v24, s20, v136
    v_cvt_pk_bf16_f32 v156, v138, v139
    v_dot2_f32_bf16 v129, v28, s20, v136
    v_cvt_pk_bf16_f32 v157, v140, v141
    v_dot2_f32_bf16 v130, v32, s20, v136
    v_cvt_pk_bf16_f32 v158, v142, v143
    v_dot2_f32_bf16 v131, v36, s20, v136
    v_cvt_pk_bf16_f32 v159, v144, v145
    v_mfma_f32_16x16x16_bf16 v[160:163], a[108:109], a[146:147], v[160:163]
    v_mfma_f32_16x16x16_bf16 v[164:167], a[110:111], a[146:147], v[164:167]
    ds_write_b128 v217, v[156:159] offset:3072
    global_load_dwordx4 v[112:115], v207, s[46:47] offset:1280 nt
    v_dot2_f32_bf16 v132, v24, s21, v137
    v_dot2_f32_bf16 v133, v28, s21, v137
    v_dot2_f32_bf16 v134, v32, s21, v137
    v_dot2_f32_bf16 v135, v36, s21, v137
    v_lshlrev_b32 v146, 16, v61
    v_and_b32 v147, 0xffff0000, v61
    v_dot2_f32_bf16 v138, v25, s20, v146
    v_cvt_pk_bf16_f32 v152, v128, v129
    v_dot2_f32_bf16 v139, v29, s20, v146
    v_cvt_pk_bf16_f32 v153, v130, v131
    v_dot2_f32_bf16 v140, v33, s20, v146
    v_cvt_pk_bf16_f32 v154, v132, v133
    v_dot2_f32_bf16 v141, v37, s20, v146
    v_cvt_pk_bf16_f32 v155, v134, v135
    v_mfma_f32_16x16x16_bf16 v[168:171], a[112:113], a[146:147], v[168:171]
    v_mfma_f32_16x16x16_bf16 v[172:175], a[114:115], a[146:147], v[172:175]
    ds_write_b128 v217, v[152:155] offset:4096
    v_dot2_f32_bf16 v142, v25, s21, v147
    v_dot2_f32_bf16 v143, v29, s21, v147
    v_dot2_f32_bf16 v144, v33, s21, v147
    v_dot2_f32_bf16 v145, v37, s21, v147
    v_lshlrev_b32 v136, 16, v62
    v_and_b32 v137, 0xffff0000, v62
    v_dot2_f32_bf16 v128, v26, s20, v136
    v_cvt_pk_bf16_f32 v156, v138, v139
    v_dot2_f32_bf16 v129, v30, s20, v136
    v_cvt_pk_bf16_f32 v157, v140, v141
    v_dot2_f32_bf16 v130, v34, s20, v136
    v_cvt_pk_bf16_f32 v158, v142, v143
    v_dot2_f32_bf16 v131, v38, s20, v136
    v_cvt_pk_bf16_f32 v159, v144, v145
    v_mfma_f32_16x16x16_bf16 v[176:179], a[116:117], a[146:147], v[176:179]
    v_mfma_f32_16x16x16_bf16 v[180:183], a[118:119], a[146:147], v[180:183]
    ds_write_b128 v217, v[156:159] offset:5120
    s_mul_hi_u32 s34, s19, 89478486
    s_mul_i32 s35, s34, 48
    s_sub_u32 s35, s19, s35
    s_mul_i32 s34, s34, 589824
    s_mul_i32 s35, s35, 6144
    s_add_u32 s34, s34, s35
    s_add_u32 s10, s4, s34
    s_addc_u32 s11, s5, 0
    s_add_u32 s12, s10, 294912
    s_addc_u32 s13, s11, 0
    s_mul_i32 s34, s19, 3072
    s_add_u32 s14, s6, s34
    s_addc_u32 s15, s7, 0
    s_add_u32 s19, s19, 4
    global_load_dwordx4 v[56:59], v208, s[14:15] offset:0 nt
    v_dot2_f32_bf16 v132, v26, s21, v137
    v_dot2_f32_bf16 v133, v30, s21, v137
    v_dot2_f32_bf16 v134, v34, s21, v137
    v_dot2_f32_bf16 v135, v38, s21, v137
    v_lshlrev_b32 v146, 16, v63
    v_and_b32 v147, 0xffff0000, v63
    v_dot2_f32_bf16 v138, v27, s20, v146
    v_cvt_pk_bf16_f32 v152, v128, v129
    v_dot2_f32_bf16 v139, v31, s20, v146
    v_cvt_pk_bf16_f32 v153, v130, v131
    v_dot2_f32_bf16 v140, v35, s20, v146
    v_cvt_pk_bf16_f32 v154, v132, v133
    v_dot2_f32_bf16 v141, v39, s20, v146
    v_cvt_pk_bf16_f32 v155, v134, v135
    v_mfma_f32_16x16x16_bf16 v[160:163], a[120:121], a[148:149], v[160:163]
    v_mfma_f32_16x16x16_bf16 v[164:167], a[122:123], a[148:149], v[164:167]
    ds_write_b128 v217, v[152:155] offset:6144
    global_load_dwordx4 v[8:11], v207, s[10:11] offset:0 nt
    v_dot2_f32_bf16 v142, v27, s21, v147
    v_dot2_f32_bf16 v143, v31, s21, v147
    v_dot2_f32_bf16 v144, v35, s21, v147
    v_dot2_f32_bf16 v145, v39, s21, v147
    s_waitcnt vmcnt(17)
    v_lshlrev_b32 v136, 16, v64
    v_and_b32 v137, 0xffff0000, v64
    v_dot2_f32_bf16 v128, v40, s20, v136
    v_cvt_pk_bf16_f32 v156, v138, v139
    v_dot2_f32_bf16 v129, v44, s20, v136
    v_cvt_pk_bf16_f32 v157, v140, v141
    v_dot2_f32_bf16 v130, v48, s20, v136
    v_cvt_pk_bf16_f32 v158, v142, v143
    v_dot2_f32_bf16 v131, v52, s20, v136
    v_cvt_pk_bf16_f32 v159, v144, v145
    v_mfma_f32_16x16x16_bf16 v[168:171], a[124:125], a[148:149], v[168:171]
    v_mfma_f32_16x16x16_bf16 v[172:175], a[126:127], a[148:149], v[172:175]
    ds_write_b128 v217, v[156:159] offset:7168
    global_load_dwordx4 v[12:15], v207, s[10:11] offset:768 nt
    v_dot2_f32_bf16 v132, v40, s21, v137
    v_dot2_f32_bf16 v133, v44, s21, v137
    v_dot2_f32_bf16 v134, v48, s21, v137
    v_dot2_f32_bf16 v135, v52, s21, v137
    v_lshlrev_b32 v146, 16, v65
    v_and_b32 v147, 0xffff0000, v65
    v_dot2_f32_bf16 v138, v41, s20, v146
    v_cvt_pk_bf16_f32 v152, v128, v129
    v_dot2_f32_bf16 v139, v45, s20, v146
    v_cvt_pk_bf16_f32 v153, v130, v131
    v_dot2_f32_bf16 v140, v49, s20, v146
    v_cvt_pk_bf16_f32 v154, v132, v133
    v_dot2_f32_bf16 v141, v53, s20, v146
    v_cvt_pk_bf16_f32 v155, v134, v135
    v_mfma_f32_16x16x16_bf16 v[176:179], a[128:129], a[148:149], v[176:179]
    v_mfma_f32_16x16x16_bf16 v[180:183], a[130:131], a[148:149], v[180:183]
    ds_write_b128 v217, v[152:155] offset:8192
    global_load_dwordx4 v[16:19], v207, s[12:13] offset:0 nt
    v_dot2_f32_bf16 v142, v41, s21, v147
    v_dot2_f32_bf16 v143, v45, s21, v147
    v_dot2_f32_bf16 v144, v49, s21, v147
    v_dot2_f32_bf16 v145, v53, s21, v147
    v_lshlrev_b32 v136, 16, v66
    v_and_b32 v137, 0xffff0000, v66
    v_dot2_f32_bf16 v128, v42, s20, v136
    v_cvt_pk_bf16_f32 v156, v138, v139
    v_dot2_f32_bf16 v129, v46, s20, v136
    v_cvt_pk_bf16_f32 v157, v140, v141
    v_dot2_f32_bf16 v130, v50, s20, v136
    v_cvt_pk_bf16_f32 v158, v142, v143
    v_dot2_f32_bf16 v131, v54, s20, v136
    v_cvt_pk_bf16_f32 v159, v144, v145
    v_mfma_f32_16x16x16_bf16 v[160:163], a[132:133], a[150:151], v[160:163]
    v_mfma_f32_16x16x16_bf16 v[164:167], a[134:135], a[150:151], v[164:167]
    ds_write_b128 v217, v[156:159] offset:9216
    global_load_dwordx4 v[20:23], v207, s[12:13] offset:768 nt
    v_dot2_f32_bf16 v132, v42, s21, v137
    v_dot2_f32_bf16 v133, v46, s21, v137
    v_dot2_f32_bf16 v134, v50, s21, v137
    v_dot2_f32_bf16 v135, v54, s21, v137
    v_lshlrev_b32 v146, 16, v67
    v_and_b32 v147, 0xffff0000, v67
    v_dot2_f32_bf16 v138, v43, s20, v146
    v_cvt_pk_bf16_f32 v152, v128, v129
    v_dot2_f32_bf16 v139, v47, s20, v146
    v_cvt_pk_bf16_f32 v153, v130, v131
    v_dot2_f32_bf16 v140, v51, s20, v146
    v_cvt_pk_bf16_f32 v154, v132, v133
    v_dot2_f32_bf16 v141, v55, s20, v146
    v_cvt_pk_bf16_f32 v155, v134, v135
    v_mfma_f32_16x16x16_bf16 v[168:171], a[136:137], a[150:151], v[168:171]
    v_mfma_f32_16x16x16_bf16 v[172:175], a[138:139], a[150:151], v[172:175]
    ds_write_b128 v217, v[152:155] offset:10240
    v_dot2_f32_bf16 v142, v43, s21, v147
    v_dot2_f32_bf16 v143, v47, s21, v147
    v_dot2_f32_bf16 v144, v51, s21, v147
    v_dot2_f32_bf16 v145, v55, s21, v147
    s_nop 0
    v_cvt_pk_bf16_f32 v156, v138, v139
    v_cvt_pk_bf16_f32 v157, v140, v141
    v_cvt_pk_bf16_f32 v158, v142, v143
    v_cvt_pk_bf16_f32 v159, v144, v145
    v_mfma_f32_16x16x16_bf16 v[176:179], a[140:141], a[150:151], v[176:179]
    v_mfma_f32_16x16x16_bf16 v[180:183], a[142:143], a[150:151], v[180:183]
    ds_write_b128 v217, v[156:159] offset:11264
    v_add_u32 v218, 0, v210
    v_add_u32 v219, 0, v211
    v_add_u32 v220, 0, v212
    s_waitcnt lgkmcnt(0)
    s_barrier
    ds_read_b64_tr_b16 a[48:49], v218 offset:0
    ds_read_b64_tr_b16 a[50:51], v219 offset:0
    ds_read_b64_tr_b16 a[52:53], v218 offset:1024
    ds_read_b64_tr_b16 a[54:55], v219 offset:1024
    ds_read_b64_tr_b16 a[56:57], v218 offset:2048
    ds_read_b64_tr_b16 a[58:59], v219 offset:2048
    ds_read_b64_tr_b16 a[60:61], v218 offset:3072
    ds_read_b64_tr_b16 a[62:63], v219 offset:3072
    ds_read_b64_tr_b16 a[64:65], v218 offset:4096
    ds_read_b64_tr_b16 a[66:67], v219 offset:4096
    ds_read_b64_tr_b16 a[68:69], v218 offset:5120
    ds_read_b64_tr_b16 a[70:71], v219 offset:5120
    ds_read_b64_tr_b16 a[72:73], v218 offset:6144
    ds_read_b64_tr_b16 a[74:75], v219 offset:6144
    ds_read_b64_tr_b16 a[76:77], v218 offset:7168
    ds_read_b64_tr_b16 a[78:79], v219 offset:7168
    ds_read_b64_tr_b16 a[80:81], v218 offset:8192
    ds_read_b64_tr_b16 a[82:83], v219 offset:8192
    ds_read_b64_tr_b16 a[84:85], v218 offset:9216
    ds_read_b64_tr_b16 a[86:87], v219 offset:9216
    ds_read_b64_tr_b16 a[88:89], v218 offset:10240
    ds_read_b64_tr_b16 a[90:91], v219 offset:10240
    ds_read_b64_tr_b16 a[92:93], v218 offset:11264
    ds_read_b64_tr_b16 a[94:95], v219 offset:11264
    s_waitcnt lgkmcnt(15)
    v_mfma_f32_16x16x32_bf16 v[192:195], a[48:51], a[48:51], 0
    ds_read_b128 a[96:99], v220 offset:0
    v_mfma_f32_16x16x32_bf16 v[192:195], a[52:55], a[52:55], v[192:195]
    ds_read_b128 a[100:103], v220 offset:4096
    global_load_dwordx4 v[60:63], v208, s[14:15] offset:256 nt
    v_mfma_f32_16x16x32_bf16 v[192:195], a[56:59], a[56:59], v[192:195]
    ds_read_b128 a[104:107], v220 offset:8192
    s_waitcnt lgkmcnt(15)
    v_mfma_f32_16x16x32_bf16 v[192:195], a[60:63], a[60:63], v[192:195]
    ds_read_b128 a[108:111], v220 offset:12288
    global_load_dwordx4 v[24:27], v207, s[10:11] offset:256 nt
    v_mfma_f32_16x16x32_bf16 v[192:195], a[64:67], a[64:67], v[192:195]
    ds_read_b128 a[112:115], v220 offset:16384
    v_mfma_f32_16x16x32_bf16 v[192:195], a[68:71], a[68:71], v[192:195]
    ds_read_b128 a[116:119], v220 offset:20480
    global_load_dwordx4 v[28:31], v207, s[10:11] offset:1024 nt
    s_waitcnt lgkmcnt(12)
    v_mfma_f32_16x16x32_bf16 v[192:195], a[72:75], a[72:75], v[192:195]
    ds_read_b128 a[120:123], v220 offset:24576
    v_mfma_f32_16x16x32_bf16 v[192:195], a[76:79], a[76:79], v[192:195]
    ds_read_b128 a[124:127], v220 offset:28672
    global_load_dwordx4 v[32:35], v207, s[12:13] offset:256 nt
    v_mfma_f32_16x16x32_bf16 v[192:195], a[80:83], a[80:83], v[192:195]
    ds_read_b128 a[128:131], v220 offset:32768
    s_waitcnt lgkmcnt(9)
    v_mfma_f32_16x16x32_bf16 v[192:195], a[84:87], a[84:87], v[192:195]
    ds_read_b128 a[132:135], v220 offset:36864
    global_load_dwordx4 v[36:39], v207, s[12:13] offset:1024 nt
    v_mfma_f32_16x16x32_bf16 v[192:195], a[88:91], a[88:91], v[192:195]
    ds_read_b128 a[136:139], v220 offset:40960
    v_mfma_f32_16x16x32_bf16 v[192:195], a[92:95], a[92:95], v[192:195]
    ds_read_b128 a[140:143], v220 offset:45056
    v_mfma_f32_16x16x32_bf16 v[188:191], a[48:51], a[152:155], 0
    v_mfma_f32_16x16x32_bf16 v[188:191], a[52:55], a[152:155], v[188:191]
    v_mfma_f32_16x16x32_bf16 v[188:191], a[56:59], a[152:155], v[188:191]
    v_mfma_f32_16x16x32_bf16 v[188:191], a[60:63], a[152:155], v[188:191]
    v_mfma_f32_16x16x32_bf16 v[188:191], a[64:67], a[152:155], v[188:191]
    v_mfma_f32_16x16x32_bf16 v[188:191], a[68:71], a[152:155], v[188:191]
    v_mfma_f32_16x16x32_bf16 v[188:191], a[72:75], a[152:155], v[188:191]
    v_mfma_f32_16x16x32_bf16 v[188:191], a[76:79], a[152:155], v[188:191]
    v_cndmask_b32 v128, 0, v192, s[26:27]
    v_mfma_f32_16x16x32_bf16 v[188:191], a[80:83], a[152:155], v[188:191]
    v_cndmask_b32 v128, v128, v193, s[28:29]
    v_mfma_f32_16x16x32_bf16 v[188:191], a[84:87], a[152:155], v[188:191]
    v_cndmask_b32 v128, v128, v194, s[30:31]
    v_mfma_f32_16x16x32_bf16 v[188:191], a[88:91], a[152:155], v[188:191]
    v_cndmask_b32 v128, v128, v195, s[32:33]
    v_mfma_f32_16x16x32_bf16 v[188:191], a[92:95], a[152:155], v[188:191]
    v_mfma_f32_16x16x32_bf16 v[184:187], a[48:51], a[0:3], 0
    v_mfma_f32_16x16x4_f32 v[196:199], v128, v205, 0
    v_mfma_f32_16x16x32_bf16 v[184:187], a[52:55], a[4:7], v[184:187]
    v_mfma_f32_16x16x32_bf16 v[184:187], a[56:59], a[8:11], v[184:187]
    v_mfma_f32_16x16x32_bf16 v[184:187], a[60:63], a[12:15], v[184:187]
    v_mfma_f32_16x16x32_bf16 v[184:187], a[64:67], a[16:19], v[184:187]
    v_mfma_f32_16x16x32_bf16 v[184:187], a[68:71], a[20:23], v[184:187]
    v_mfma_f32_16x16x32_bf16 v[184:187], a[72:75], a[24:27], v[184:187]
    v_mul_f32 v188, s23, v188
    v_mfma_f32_16x16x32_bf16 v[184:187], a[76:79], a[28:31], v[184:187]
    v_mul_f32 v189, s23, v189
    v_mfma_f32_16x16x32_bf16 v[184:187], a[80:83], a[32:35], v[184:187]
    v_mul_f32 v190, s23, v190
    v_mfma_f32_16x16x32_bf16 v[184:187], a[84:87], a[36:39], v[184:187]
    v_mul_f32 v191, s23, v191
    v_mfma_f32_16x16x32_bf16 v[184:187], a[88:91], a[40:43], v[184:187]
    v_fma_f32 v128, -v188, v188, v206
    v_fma_f32 v129, -v189, v189, v206
    v_mfma_f32_16x16x32_bf16 v[184:187], a[92:95], a[44:47], v[184:187]
    v_fma_f32 v130, -v190, v190, v206
    v_fma_f32 v131, -v191, v191, v206
    v_fma_f32 v196, v196, s23, v128
    v_fma_f32 v197, v197, s23, v129
    v_fma_f32 v198, v198, s23, v130
    v_fma_f32 v199, v199, s23, v131
    v_rsq_f32 v196, v196
    v_rsq_f32 v197, v197
    v_rsq_f32 v198, v198
    v_rsq_f32 v199, v199
    v_pk_fma_f32 v[184:185], v[188:189], v[204:205], v[184:185] op_sel_hi:[1,0,1] neg_lo:[1,0,0] neg_hi:[1,0,0]
    v_pk_fma_f32 v[186:187], v[190:191], v[204:205], v[186:187] op_sel_hi:[1,0,1] neg_lo:[1,0,0] neg_hi:[1,0,0]
    v_pk_fma_f32 v[136:137], v[184:185], v[196:197], v[202:203] op_sel_hi:[1,1,0] neg_lo:[0,0,1] neg_hi:[0,0,1]
    v_pk_fma_f32 v[138:139], v[186:187], v[198:199], v[202:203] op_sel_hi:[1,1,0] neg_lo:[0,0,1] neg_hi:[0,0,1]
    v_max3_f32 v128, v136, v137, v138
    v_max_f32 v128, v128, v139
    v_cmp_lt_f32 vcc, s61, v128
    v_exp_f32 v136, v136
    v_exp_f32 v137, v137
    v_exp_f32 v138, v138
    v_exp_f32 v139, v139
    s_nop 0
    v_pk_mul_f32 v[132:133], v[136:137], v[196:197]
    v_pk_mul_f32 v[134:135], v[138:139], v[198:199]
    v_cvt_pk_bf16_f32 v200, v132, v133
    v_cvt_pk_bf16_f32 v201, v134, v135
    ds_write_b64 v213, v[200:201] offset:12288
    v_cndmask_b32 v128, 0, 1, vcc
    ds_write_b32 v254, v128 offset:10816
    v_add_f32 v136, v136, v137
    v_add_f32 v138, v138, v139
    v_lshlrev_b32 v132, 16, v200
    v_and_b32 v133, 0xffff0000, v200
    v_lshlrev_b32 v134, 16, v201
    v_and_b32 v135, 0xffff0000, v201
    v_add_f32 v140, v136, v138
    v_mul_f32 v141, v132, v188
    v_mul_f32 v132, v133, v189
    v_fmac_f32 v141, v134, v190
    v_fmac_f32 v132, v135, v191
    v_add_f32 v141, v141, v132
    s_waitcnt lgkmcnt(0)
    s_barrier
    ds_read_b128 v[128:131], v255 offset:10816
    ds_read_b64 a[144:145], v214 offset:12288
    ds_read_b64 a[146:147], v214 offset:12800
    ds_read_b64 a[148:149], v214 offset:13312
    ds_read_b64 a[150:151], v214 offset:13824
    s_waitcnt lgkmcnt(4)
    v_or3_b32 v128, v128, v129, v130
    v_or_b32 v128, v128, v131
    v_cmp_ne_u32 vcc, 0, v128
    s_cbranch_vccz BJ_35
    v_mul_f32 v136, v184, v196
    v_mul_f32 v137, v185, v197
    v_mul_f32 v138, v186, v198
    v_mul_f32 v139, v187, v199
    v_max3_f32 v128, v136, v137, v138
    v_max_f32 v128, v128, v139
    ds_max_f32 v215, v128
    s_waitcnt lgkmcnt(0)
    s_barrier
    ds_read_b32 v129, v215
    s_waitcnt lgkmcnt(0)
    v_sub_f32 v130, v202, v129
    v_sub_f32 v136, v136, v129
    v_sub_f32 v137, v137, v129
    v_sub_f32 v138, v138, v129
    v_sub_f32 v139, v139, v129
    v_exp_f32 v130, v130
    v_mov_b32 v202, v129
    v_exp_f32 v136, v136
    v_exp_f32 v137, v137
    v_exp_f32 v138, v138
    v_exp_f32 v139, v139
    s_nop 0
    v_pk_mul_f32 v[132:133], v[136:137], v[196:197]
    v_pk_mul_f32 v[134:135], v[138:139], v[198:199]
    v_cvt_pk_bf16_f32 v200, v132, v133
    v_cvt_pk_bf16_f32 v201, v134, v135
    ds_write_b64 v213, v[200:201] offset:12288
    v_mul_f32 v203, v203, v130
    v_mul_f32 v221, v221, v130
    v_pk_mul_f32 v[160:161], v[160:161], v[130:131] op_sel_hi:[1,0]
    v_pk_mul_f32 v[162:163], v[162:163], v[130:131] op_sel_hi:[1,0]
    v_pk_mul_f32 v[164:165], v[164:165], v[130:131] op_sel_hi:[1,0]
    v_pk_mul_f32 v[166:167], v[166:167], v[130:131] op_sel_hi:[1,0]
    v_pk_mul_f32 v[168:169], v[168:169], v[130:131] op_sel_hi:[1,0]
    v_pk_mul_f32 v[170:171], v[170:171], v[130:131] op_sel_hi:[1,0]
    v_pk_mul_f32 v[172:173], v[172:173], v[130:131] op_sel_hi:[1,0]
    v_pk_mul_f32 v[174:175], v[174:175], v[130:131] op_sel_hi:[1,0]
    v_pk_mul_f32 v[176:177], v[176:177], v[130:131] op_sel_hi:[1,0]
    v_pk_mul_f32 v[178:179], v[178:179], v[130:131] op_sel_hi:[1,0]
    v_pk_mul_f32 v[180:181], v[180:181], v[130:131] op_sel_hi:[1,0]
    v_pk_mul_f32 v[182:183], v[182:183], v[130:131] op_sel_hi:[1,0]
    v_add_f32 v136, v136, v137
    v_add_f32 v138, v138, v139
    v_lshlrev_b32 v132, 16, v200
    v_and_b32 v133, 0xffff0000, v200
    v_lshlrev_b32 v134, 16, v201
    v_and_b32 v135, 0xffff0000, v201
    v_add_f32 v140, v136, v138
    v_mul_f32 v141, v132, v188
    v_mul_f32 v132, v133, v189
    v_fmac_f32 v141, v134, v190
    v_fmac_f32 v132, v135, v191
    v_add_f32 v141, v141, v132
    s_waitcnt lgkmcnt(0)
    s_barrier
    ds_read_b64 a[144:145], v214 offset:12288
    ds_read_b64 a[146:147], v214 offset:12800
    ds_read_b64 a[148:149], v214 offset:13312
    ds_read_b64 a[150:151], v214 offset:13824
BJ_35:
    v_add_f32 v203, v203, v140
    v_add_f32 v221, v221, v141
    v_add_u32 v217, 49152, v209
    s_waitcnt lgkmcnt(0)
    s_waitcnt vmcnt(20)
    v_lshlrev_b32 v136, 16, v116
    v_and_b32 v137, 0xffff0000, v116
    v_dot2_f32_bf16 v128, v68, s20, v136
    v_dot2_f32_bf16 v129, v72, s20, v136
    v_dot2_f32_bf16 v130, v76, s20, v136
    v_dot2_f32_bf16 v131, v80, s20, v136
    global_load_dwordx4 v[64:67], v208, s[14:15] offset:512 nt
    v_dot2_f32_bf16 v132, v68, s21, v137
    v_dot2_f32_bf16 v133, v72, s21, v137
    v_dot2_f32_bf16 v134, v76, s21, v137
    v_dot2_f32_bf16 v135, v80, s21, v137
    v_lshlrev_b32 v146, 16, v117
    v_and_b32 v147, 0xffff0000, v117
    v_dot2_f32_bf16 v138, v69, s20, v146
    v_cvt_pk_bf16_f32 v152, v128, v129
    v_dot2_f32_bf16 v139, v73, s20, v146
    v_cvt_pk_bf16_f32 v153, v130, v131
    v_dot2_f32_bf16 v140, v77, s20, v146
    v_cvt_pk_bf16_f32 v154, v132, v133
    v_dot2_f32_bf16 v141, v81, s20, v146
    v_cvt_pk_bf16_f32 v155, v134, v135
    v_mfma_f32_16x16x16_bf16 v[160:163], a[96:97], a[144:145], v[160:163]
    v_mfma_f32_16x16x16_bf16 v[164:167], a[98:99], a[144:145], v[164:167]
    ds_write_b128 v217, v[152:155] offset:0
    global_load_dwordx4 v[40:43], v207, s[10:11] offset:512 nt
    v_dot2_f32_bf16 v142, v69, s21, v147
    v_dot2_f32_bf16 v143, v73, s21, v147
    v_dot2_f32_bf16 v144, v77, s21, v147
    v_dot2_f32_bf16 v145, v81, s21, v147
    v_lshlrev_b32 v136, 16, v118
    v_and_b32 v137, 0xffff0000, v118
    v_dot2_f32_bf16 v128, v70, s20, v136
    v_cvt_pk_bf16_f32 v156, v138, v139
    v_dot2_f32_bf16 v129, v74, s20, v136
    v_cvt_pk_bf16_f32 v157, v140, v141
    v_dot2_f32_bf16 v130, v78, s20, v136
    v_cvt_pk_bf16_f32 v158, v142, v143
    v_dot2_f32_bf16 v131, v82, s20, v136
    v_cvt_pk_bf16_f32 v159, v144, v145
    v_mfma_f32_16x16x16_bf16 v[168:171], a[100:101], a[144:145], v[168:171]
    v_mfma_f32_16x16x16_bf16 v[172:175], a[102:103], a[144:145], v[172:175]
    ds_write_b128 v217, v[156:159] offset:1024
    global_load_dwordx4 v[44:47], v207, s[10:11] offset:1280 nt
    v_dot2_f32_bf16 v132, v70, s21, v137
    v_dot2_f32_bf16 v133, v74, s21, v137
    v_dot2_f32_bf16 v134, v78, s21, v137
    v_dot2_f32_bf16 v135, v82, s21, v137
    v_lshlrev_b32 v146, 16, v119
    v_and_b32 v147, 0xffff0000, v119
    v_dot2_f32_bf16 v138, v71, s20, v146
    v_cvt_pk_bf16_f32 v152, v128, v129
    v_dot2_f32_bf16 v139, v75, s20, v146
    v_cvt_pk_bf16_f32 v153, v130, v131
    v_dot2_f32_bf16 v140, v79, s20, v146
    v_cvt_pk_bf16_f32 v154, v132, v133
    v_dot2_f32_bf16 v141, v83, s20, v146
    v_cvt_pk_bf16_f32 v155, v134, v135
    v_mfma_f32_16x16x16_bf16 v[176:179], a[104:105], a[144:145], v[176:179]
    v_mfma_f32_16x16x16_bf16 v[180:183], a[106:107], a[144:145], v[180:183]
    ds_write_b128 v217, v[152:155] offset:2048
    global_load_dwordx4 v[48:51], v207, s[12:13] offset:512 nt
    v_dot2_f32_bf16 v142, v71, s21, v147
    v_dot2_f32_bf16 v143, v75, s21, v147
    v_dot2_f32_bf16 v144, v79, s21, v147
    v_dot2_f32_bf16 v145, v83, s21, v147
    s_waitcnt vmcnt(19)
    v_lshlrev_b32 v136, 16, v120
    v_and_b32 v137, 0xffff0000, v120
    v_dot2_f32_bf16 v128, v84, s20, v136
    v_cvt_pk_bf16_f32 v156, v138, v139
    v_dot2_f32_bf16 v129, v88, s20, v136
    v_cvt_pk_bf16_f32 v157, v140, v141
    v_dot2_f32_bf16 v130, v92, s20, v136
    v_cvt_pk_bf16_f32 v158, v142, v143
    v_dot2_f32_bf16 v131, v96, s20, v136
    v_cvt_pk_bf16_f32 v159, v144, v145
    v_mfma_f32_16x16x16_bf16 v[160:163], a[108:109], a[146:147], v[160:163]
    v_mfma_f32_16x16x16_bf16 v[164:167], a[110:111], a[146:147], v[164:167]
    ds_write_b128 v217, v[156:159] offset:3072
    global_load_dwordx4 v[52:55], v207, s[12:13] offset:1280 nt
    v_dot2_f32_bf16 v132, v84, s21, v137
    v_dot2_f32_bf16 v133, v88, s21, v137
    v_dot2_f32_bf16 v134, v92, s21, v137
    v_dot2_f32_bf16 v135, v96, s21, v137
    v_lshlrev_b32 v146, 16, v121
    v_and_b32 v147, 0xffff0000, v121
    v_dot2_f32_bf16 v138, v85, s20, v146
    v_cvt_pk_bf16_f32 v152, v128, v129
    v_dot2_f32_bf16 v139, v89, s20, v146
    v_cvt_pk_bf16_f32 v153, v130, v131
    v_dot2_f32_bf16 v140, v93, s20, v146
    v_cvt_pk_bf16_f32 v154, v132, v133
    v_dot2_f32_bf16 v141, v97, s20, v146
    v_cvt_pk_bf16_f32 v155, v134, v135
    v_mfma_f32_16x16x16_bf16 v[168:171], a[112:113], a[146:147], v[168:171]
    v_mfma_f32_16x16x16_bf16 v[172:175], a[114:115], a[146:147], v[172:175]
    ds_write_b128 v217, v[152:155] offset:4096
    v_dot2_f32_bf16 v142, v85, s21, v147
    v_dot2_f32_bf16 v143, v89, s21, v147
    v_dot2_f32_bf16 v144, v93, s21, v147
    v_dot2_f32_bf16 v145, v97, s21, v147
    v_lshlrev_b32 v136, 16, v122
    v_and_b32 v137, 0xffff0000, v122
    v_dot2_f32_bf16 v128, v86, s20, v136
    v_cvt_pk_bf16_f32 v156, v138, v139
    v_dot2_f32_bf16 v129, v90, s20, v136
    v_cvt_pk_bf16_f32 v157, v140, v141
    v_dot2_f32_bf16 v130, v94, s20, v136
    v_cvt_pk_bf16_f32 v158, v142, v143
    v_dot2_f32_bf16 v131, v98, s20, v136
    v_cvt_pk_bf16_f32 v159, v144, v145
    v_mfma_f32_16x16x16_bf16 v[176:179], a[116:117], a[146:147], v[176:179]
    v_mfma_f32_16x16x16_bf16 v[180:183], a[118:119], a[146:147], v[180:183]
    ds_write_b128 v217, v[156:159] offset:5120
    v_dot2_f32_bf16 v132, v86, s21, v137
    v_dot2_f32_bf16 v133, v90, s21, v137
    v_dot2_f32_bf16 v134, v94, s21, v137
    v_dot2_f32_bf16 v135, v98, s21, v137
    v_lshlrev_b32 v146, 16, v123
    v_and_b32 v147, 0xffff0000, v123
    v_dot2_f32_bf16 v138, v87, s20, v146
    v_cvt_pk_bf16_f32 v152, v128, v129
    v_dot2_f32_bf16 v139, v91, s20, v146
    v_cvt_pk_bf16_f32 v153, v130, v131
    v_dot2_f32_bf16 v140, v95, s20, v146
    v_cvt_pk_bf16_f32 v154, v132, v133
    v_dot2_f32_bf16 v141, v99, s20, v146
    v_cvt_pk_bf16_f32 v155, v134, v135
    v_mfma_f32_16x16x16_bf16 v[160:163], a[120:121], a[148:149], v[160:163]
    v_mfma_f32_16x16x16_bf16 v[164:167], a[122:123], a[148:149], v[164:167]
    ds_write_b128 v217, v[152:155] offset:6144
    v_dot2_f32_bf16 v142, v87, s21, v147
    v_dot2_f32_bf16 v143, v91, s21, v147
    v_dot2_f32_bf16 v144, v95, s21, v147
    v_dot2_f32_bf16 v145, v99, s21, v147
    s_waitcnt vmcnt(15)
    v_lshlrev_b32 v136, 16, v124
    v_and_b32 v137, 0xffff0000, v124
    v_dot2_f32_bf16 v128, v100, s20, v136
    v_cvt_pk_bf16_f32 v156, v138, v139
    v_dot2_f32_bf16 v129, v104, s20, v136
    v_cvt_pk_bf16_f32 v157, v140, v141
    v_dot2_f32_bf16 v130, v108, s20, v136
    v_cvt_pk_bf16_f32 v158, v142, v143
    v_dot2_f32_bf16 v131, v112, s20, v136
    v_cvt_pk_bf16_f32 v159, v144, v145
    v_mfma_f32_16x16x16_bf16 v[168:171], a[124:125], a[148:149], v[168:171]
    v_mfma_f32_16x16x16_bf16 v[172:175], a[126:127], a[148:149], v[172:175]
    ds_write_b128 v217, v[156:159] offset:7168
    v_dot2_f32_bf16 v132, v100, s21, v137
    v_dot2_f32_bf16 v133, v104, s21, v137
    v_dot2_f32_bf16 v134, v108, s21, v137
    v_dot2_f32_bf16 v135, v112, s21, v137
    v_lshlrev_b32 v146, 16, v125
    v_and_b32 v147, 0xffff0000, v125
    v_dot2_f32_bf16 v138, v101, s20, v146
    v_cvt_pk_bf16_f32 v152, v128, v129
    v_dot2_f32_bf16 v139, v105, s20, v146
    v_cvt_pk_bf16_f32 v153, v130, v131
    v_dot2_f32_bf16 v140, v109, s20, v146
    v_cvt_pk_bf16_f32 v154, v132, v133
    v_dot2_f32_bf16 v141, v113, s20, v146
    v_cvt_pk_bf16_f32 v155, v134, v135
    v_mfma_f32_16x16x16_bf16 v[176:179], a[128:129], a[148:149], v[176:179]
    v_mfma_f32_16x16x16_bf16 v[180:183], a[130:131], a[148:149], v[180:183]
    ds_write_b128 v217, v[152:155] offset:8192
    v_dot2_f32_bf16 v142, v101, s21, v147
    v_dot2_f32_bf16 v143, v105, s21, v147
    v_dot2_f32_bf16 v144, v109, s21, v147
    v_dot2_f32_bf16 v145, v113, s21, v147
    v_lshlrev_b32 v136, 16, v126
    v_and_b32 v137, 0xffff0000, v126
    v_dot2_f32_bf16 v128, v102, s20, v136
    v_cvt_pk_bf16_f32 v156, v138, v139
    v_dot2_f32_bf16 v129, v106, s20, v136
    v_cvt_pk_bf16_f32 v157, v140, v141
    v_dot2_f32_bf16 v130, v110, s20, v136
    v_cvt_pk_bf16_f32 v158, v142, v143
    v_dot2_f32_bf16 v131, v114, s20, v136
    v_cvt_pk_bf16_f32 v159, v144, v145
    v_mfma_f32_16x16x16_bf16 v[160:163], a[132:133], a[150:151], v[160:163]
    v_mfma_f32_16x16x16_bf16 v[164:167], a[134:135], a[150:151], v[164:167]
    ds_write_b128 v217, v[156:159] offset:9216
    v_dot2_f32_bf16 v132, v102, s21, v137
    v_dot2_f32_bf16 v133, v106, s21, v137
    v_dot2_f32_bf16 v134, v110, s21, v137
    v_dot2_f32_bf16 v135, v114, s21, v137
    v_lshlrev_b32 v146, 16, v127
    v_and_b32 v147, 0xffff0000, v127
    v_dot2_f32_bf16 v138, v103, s20, v146
    v_cvt_pk_bf16_f32 v152, v128, v129
    v_dot2_f32_bf16 v139, v107, s20, v146
    v_cvt_pk_bf16_f32 v153, v130, v131
    v_dot2_f32_bf16 v140, v111, s20, v146
    v_cvt_pk_bf16_f32 v154, v132, v133
    v_dot2_f32_bf16 v141, v115, s20, v146
    v_cvt_pk_bf16_f32 v155, v134, v135
    v_mfma_f32_16x16x16_bf16 v[168:171], a[136:137], a[150:151], v[168:171]
    v_mfma_f32_16x16x16_bf16 v[172:175], a[138:139], a[150:151], v[172:175]
    ds_write_b128 v217, v[152:155] offset:10240
    v_dot2_f32_bf16 v142, v103, s21, v147
    v_dot2_f32_bf16 v143, v107, s21, v147
    v_dot2_f32_bf16 v144, v111, s21, v147
    v_dot2_f32_bf16 v145, v115, s21, v147
    s_nop 0
    v_cvt_pk_bf16_f32 v156, v138, v139
    v_cvt_pk_bf16_f32 v157, v140, v141
    v_cvt_pk_bf16_f32 v158, v142, v143
    v_cvt_pk_bf16_f32 v159, v144, v145
    v_mfma_f32_16x16x16_bf16 v[176:179], a[140:141], a[150:151], v[176:179]
    v_mfma_f32_16x16x16_bf16 v[180:183], a[142:143], a[150:151], v[180:183]
    ds_write_b128 v217, v[156:159] offset:11264
    v_add_u32 v218, 49152, v210
    v_add_u32 v219, 49152, v211
    v_add_u32 v220, 49152, v212
    s_waitcnt lgkmcnt(0)
    s_barrier
    ds_read_b64_tr_b16 a[48:49], v218 offset:0
    ds_read_b64_tr_b16 a[50:51], v219 offset:0
    ds_read_b64_tr_b16 a[52:53], v218 offset:1024
    ds_read_b64_tr_b16 a[54:55], v219 offset:1024
    ds_read_b64_tr_b16 a[56:57], v218 offset:2048
    ds_read_b64_tr_b16 a[58:59], v219 offset:2048
    ds_read_b64_tr_b16 a[60:61], v218 offset:3072
    ds_read_b64_tr_b16 a[62:63], v219 offset:3072
    ds_read_b64_tr_b16 a[64:65], v218 offset:4096
    ds_read_b64_tr_b16 a[66:67], v219 offset:4096
    ds_read_b64_tr_b16 a[68:69], v218 offset:5120
    ds_read_b64_tr_b16 a[70:71], v219 offset:5120
    ds_read_b64_tr_b16 a[72:73], v218 offset:6144
    ds_read_b64_tr_b16 a[74:75], v219 offset:6144
    ds_read_b64_tr_b16 a[76:77], v218 offset:7168
    ds_read_b64_tr_b16 a[78:79], v219 offset:7168
    ds_read_b64_tr_b16 a[80:81], v218 offset:8192
    ds_read_b64_tr_b16 a[82:83], v219 offset:8192
    ds_read_b64_tr_b16 a[84:85], v218 offset:9216
    ds_read_b64_tr_b16 a[86:87], v219 offset:9216
    ds_read_b64_tr_b16 a[88:89], v218 offset:10240
    ds_read_b64_tr_b16 a[90:91], v219 offset:10240
    ds_read_b64_tr_b16 a[92:93], v218 offset:11264
    ds_read_b64_tr_b16 a[94:95], v219 offset:11264
    s_waitcnt lgkmcnt(15)
    v_mfma_f32_16x16x32_bf16 v[192:195], a[48:51], a[48:51], 0
    ds_read_b128 a[96:99], v220 offset:0
    v_mfma_f32_16x16x32_bf16 v[192:195], a[52:55], a[52:55], v[192:195]
    ds_read_b128 a[100:103], v220 offset:4096
    v_mfma_f32_16x16x32_bf16 v[192:195], a[56:59], a[56:59], v[192:195]
    ds_read_b128 a[104:107], v220 offset:8192
    s_waitcnt lgkmcnt(15)
    v_mfma_f32_16x16x32_bf16 v[192:195], a[60:63], a[60:63], v[192:195]
    ds_read_b128 a[108:111], v220 offset:12288
    v_mfma_f32_16x16x32_bf16 v[192:195], a[64:67], a[64:67], v[192:195]
    ds_read_b128 a[112:115], v220 offset:16384
    v_mfma_f32_16x16x32_bf16 v[192:195], a[68:71], a[68:71], v[192:195]
    ds_read_b128 a[116:119], v220 offset:20480
    s_waitcnt lgkmcnt(12)
    v_mfma_f32_16x16x32_bf16 v[192:195], a[72:75], a[72:75], v[192:195]
    ds_read_b128 a[120:123], v220 offset:24576
    v_mfma_f32_16x16x32_bf16 v[192:195], a[76:79], a[76:79], v[192:195]
    ds_read_b128 a[124:127], v220 offset:28672
    v_mfma_f32_16x16x32_bf16 v[192:195], a[80:83], a[80:83], v[192:195]
    ds_read_b128 a[128:131], v220 offset:32768
    s_waitcnt lgkmcnt(9)
    v_mfma_f32_16x16x32_bf16 v[192:195], a[84:87], a[84:87], v[192:195]
    ds_read_b128 a[132:135], v220 offset:36864
    v_mfma_f32_16x16x32_bf16 v[192:195], a[88:91], a[88:91], v[192:195]
    ds_read_b128 a[136:139], v220 offset:40960
    v_mfma_f32_16x16x32_bf16 v[192:195], a[92:95], a[92:95], v[192:195]
    ds_read_b128 a[140:143], v220 offset:45056
    v_mfma_f32_16x16x32_bf16 v[188:191], a[48:51], a[152:155], 0
    v_mfma_f32_16x16x32_bf16 v[188:191], a[52:55], a[152:155], v[188:191]
    v_mfma_f32_16x16x32_bf16 v[188:191], a[56:59], a[152:155], v[188:191]
    v_mfma_f32_16x16x32_bf16 v[188:191], a[60:63], a[152:155], v[188:191]
    v_mfma_f32_16x16x32_bf16 v[188:191], a[64:67], a[152:155], v[188:191]
    v_mfma_f32_16x16x32_bf16 v[188:191], a[68:71], a[152:155], v[188:191]
    v_mfma_f32_16x16x32_bf16 v[188:191], a[72:75], a[152:155], v[188:191]
    v_mfma_f32_16x16x32_bf16 v[188:191], a[76:79], a[152:155], v[188:191]
    v_cndmask_b32 v128, 0, v192, s[26:27]
    v_mfma_f32_16x16x32_bf16 v[188:191], a[80:83], a[152:155], v[188:191]
    v_cndmask_b32 v128, v128, v193, s[28:29]
    v_mfma_f32_16x16x32_bf16 v[188:191], a[84:87], a[152:155], v[188:191]
    v_cndmask_b32 v128, v128, v194, s[30:31]
    v_mfma_f32_16x16x32_bf16 v[188:191], a[88:91], a[152:155], v[188:191]
    v_cndmask_b32 v128, v128, v195, s[32:33]
    v_mfma_f32_16x16x32_bf16 v[188:191], a[92:95], a[152:155], v[188:191]
    v_mfma_f32_16x16x32_bf16 v[184:187], a[48:51], a[0:3], 0
    v_mfma_f32_16x16x4_f32 v[196:199], v128, v205, 0
    v_mfma_f32_16x16x32_bf16 v[184:187], a[52:55], a[4:7], v[184:187]
    v_mfma_f32_16x16x32_bf16 v[184:187], a[56:59], a[8:11], v[184:187]
    v_mfma_f32_16x16x32_bf16 v[184:187], a[60:63], a[12:15], v[184:187]
    v_mfma_f32_16x16x32_bf16 v[184:187], a[64:67], a[16:19], v[184:187]
    v_mfma_f32_16x16x32_bf16 v[184:187], a[68:71], a[20:23], v[184:187]
    v_mfma_f32_16x16x32_bf16 v[184:187], a[72:75], a[24:27], v[184:187]
    v_mul_f32 v188, s23, v188
    v_mfma_f32_16x16x32_bf16 v[184:187], a[76:79], a[28:31], v[184:187]
    v_mul_f32 v189, s23, v189
    v_mfma_f32_16x16x32_bf16 v[184:187], a[80:83], a[32:35], v[184:187]
    v_mul_f32 v190, s23, v190
    v_mfma_f32_16x16x32_bf16 v[184:187], a[84:87], a[36:39], v[184:187]
    v_mul_f32 v191, s23, v191
    v_mfma_f32_16x16x32_bf16 v[184:187], a[88:91], a[40:43], v[184:187]
    v_fma_f32 v128, -v188, v188, v206
    v_fma_f32 v129, -v189, v189, v206
    v_mfma_f32_16x16x32_bf16 v[184:187], a[92:95], a[44:47], v[184:187]
    v_fma_f32 v130, -v190, v190, v206
    v_fma_f32 v131, -v191, v191, v206
    v_fma_f32 v196, v196, s23, v128
    v_fma_f32 v197, v197, s23, v129
    v_fma_f32 v198, v198, s23, v130
    v_fma_f32 v199, v199, s23, v131
    v_rsq_f32 v196, v196
    v_rsq_f32 v197, v197
    v_rsq_f32 v198, v198
    v_rsq_f32 v199, v199
    v_pk_fma_f32 v[184:185], v[188:189], v[204:205], v[184:185] op_sel_hi:[1,0,1] neg_lo:[1,0,0] neg_hi:[1,0,0]
    v_pk_fma_f32 v[186:187], v[190:191], v[204:205], v[186:187] op_sel_hi:[1,0,1] neg_lo:[1,0,0] neg_hi:[1,0,0]
    v_pk_fma_f32 v[136:137], v[184:185], v[196:197], v[202:203] op_sel_hi:[1,1,0] neg_lo:[0,0,1] neg_hi:[0,0,1]
    v_pk_fma_f32 v[138:139], v[186:187], v[198:199], v[202:203] op_sel_hi:[1,1,0] neg_lo:[0,0,1] neg_hi:[0,0,1]
    v_max3_f32 v128, v136, v137, v138
    v_max_f32 v128, v128, v139
    v_cmp_lt_f32 vcc, s61, v128
    v_exp_f32 v136, v136
    v_exp_f32 v137, v137
    v_exp_f32 v138, v138
    v_exp_f32 v139, v139
    s_nop 0
    v_pk_mul_f32 v[132:133], v[136:137], v[196:197]
    v_pk_mul_f32 v[134:135], v[138:139], v[198:199]
    v_cvt_pk_bf16_f32 v200, v132, v133
    v_cvt_pk_bf16_f32 v201, v134, v135
    ds_write_b64 v213, v[200:201] offset:0
    v_cndmask_b32 v128, 0, 1, vcc
    ds_write_b32 v254, v128 offset:0
    v_add_f32 v136, v136, v137
    v_add_f32 v138, v138, v139
    v_lshlrev_b32 v132, 16, v200
    v_and_b32 v133, 0xffff0000, v200
    v_lshlrev_b32 v134, 16, v201
    v_and_b32 v135, 0xffff0000, v201
    v_add_f32 v140, v136, v138
    v_mul_f32 v141, v132, v188
    v_mul_f32 v132, v133, v189
    v_fmac_f32 v141, v134, v190
    v_fmac_f32 v132, v135, v191
    v_add_f32 v141, v141, v132
    s_waitcnt lgkmcnt(0)
    s_barrier
    ds_read_b128 v[128:131], v255 offset:0
    ds_read_b64 a[144:145], v214 offset:0
    ds_read_b64 a[146:147], v214 offset:512
    ds_read_b64 a[148:149], v214 offset:1024
    ds_read_b64 a[150:151], v214 offset:1536
    s_waitcnt lgkmcnt(4)
    v_or3_b32 v128, v128, v129, v130
    v_or_b32 v128, v128, v131
    v_cmp_ne_u32 vcc, 0, v128
    s_cbranch_vccz BJ_37
    v_mul_f32 v136, v184, v196
    v_mul_f32 v137, v185, v197
    v_mul_f32 v138, v186, v198
    v_mul_f32 v139, v187, v199
    v_max3_f32 v128, v136, v137, v138
    v_max_f32 v128, v128, v139
    ds_max_f32 v215, v128
    s_waitcnt lgkmcnt(0)
    s_barrier
    ds_read_b32 v129, v215
    s_waitcnt lgkmcnt(0)
    v_sub_f32 v130, v202, v129
    v_sub_f32 v136, v136, v129
    v_sub_f32 v137, v137, v129
    v_sub_f32 v138, v138, v129
    v_sub_f32 v139, v139, v129
    v_exp_f32 v130, v130
    v_mov_b32 v202, v129
    v_exp_f32 v136, v136
    v_exp_f32 v137, v137
    v_exp_f32 v138, v138
    v_exp_f32 v139, v139
    s_nop 0
    v_pk_mul_f32 v[132:133], v[136:137], v[196:197]
    v_pk_mul_f32 v[134:135], v[138:139], v[198:199]
    v_cvt_pk_bf16_f32 v200, v132, v133
    v_cvt_pk_bf16_f32 v201, v134, v135
    ds_write_b64 v213, v[200:201] offset:0
    v_mul_f32 v203, v203, v130
    v_mul_f32 v221, v221, v130
    v_pk_mul_f32 v[160:161], v[160:161], v[130:131] op_sel_hi:[1,0]
    v_pk_mul_f32 v[162:163], v[162:163], v[130:131] op_sel_hi:[1,0]
    v_pk_mul_f32 v[164:165], v[164:165], v[130:131] op_sel_hi:[1,0]
    v_pk_mul_f32 v[166:167], v[166:167], v[130:131] op_sel_hi:[1,0]
    v_pk_mul_f32 v[168:169], v[168:169], v[130:131] op_sel_hi:[1,0]
    v_pk_mul_f32 v[170:171], v[170:171], v[130:131] op_sel_hi:[1,0]
    v_pk_mul_f32 v[172:173], v[172:173], v[130:131] op_sel_hi:[1,0]
    v_pk_mul_f32 v[174:175], v[174:175], v[130:131] op_sel_hi:[1,0]
    v_pk_mul_f32 v[176:177], v[176:177], v[130:131] op_sel_hi:[1,0]
    v_pk_mul_f32 v[178:179], v[178:179], v[130:131] op_sel_hi:[1,0]
    v_pk_mul_f32 v[180:181], v[180:181], v[130:131] op_sel_hi:[1,0]
    v_pk_mul_f32 v[182:183], v[182:183], v[130:131] op_sel_hi:[1,0]
    v_add_f32 v136, v136, v137
    v_add_f32 v138, v138, v139
    v_lshlrev_b32 v132, 16, v200
    v_and_b32 v133, 0xffff0000, v200
    v_lshlrev_b32 v134, 16, v201
    v_and_b32 v135, 0xffff0000, v201
    v_add_f32 v140, v136, v138
    v_mul_f32 v141, v132, v188
    v_mul_f32 v132, v133, v189
    v_fmac_f32 v141, v134, v190
    v_fmac_f32 v132, v135, v191
    v_add_f32 v141, v141, v132
    s_waitcnt lgkmcnt(0)
    s_barrier
    ds_read_b64 a[144:145], v214 offset:0
    ds_read_b64 a[146:147], v214 offset:512
    ds_read_b64 a[148:149], v214 offset:1024
    ds_read_b64 a[150:151], v214 offset:1536
BJ_37:
    v_add_f32 v203, v203, v140
    v_add_f32 v221, v221, v141
    v_add_u32 v217, 98304, v209
    s_waitcnt lgkmcnt(0)
    s_waitcnt vmcnt(10)
    v_lshlrev_b32 v136, 16, v56
    v_and_b32 v137, 0xffff0000, v56
    v_dot2_f32_bf16 v128, v8, s20, v136
    v_dot2_f32_bf16 v129, v12, s20, v136
    v_dot2_f32_bf16 v130, v16, s20, v136
    v_dot2_f32_bf16 v131, v20, s20, v136
    v_dot2_f32_bf16 v132, v8, s21, v137
    v_dot2_f32_bf16 v133, v12, s21, v137
    v_dot2_f32_bf16 v134, v16, s21, v137
    v_dot2_f32_bf16 v135, v20, s21, v137
    v_lshlrev_b32 v146, 16, v57
    v_and_b32 v147, 0xffff0000, v57
    v_dot2_f32_bf16 v138, v9, s20, v146
    v_cvt_pk_bf16_f32 v152, v128, v129
    v_dot2_f32_bf16 v139, v13, s20, v146
    v_cvt_pk_bf16_f32 v153, v130, v131
    v_dot2_f32_bf16 v140, v17, s20, v146
    v_cvt_pk_bf16_f32 v154, v132, v133
    v_dot2_f32_bf16 v141, v21, s20, v146
    v_cvt_pk_bf16_f32 v155, v134, v135
    v_mfma_f32_16x16x16_bf16 v[160:163], a[96:97], a[144:145], v[160:163]
    v_mfma_f32_16x16x16_bf16 v[164:167], a[98:99], a[144:145], v[164:167]
    ds_write_b128 v217, v[152:155] offset:0
    v_dot2_f32_bf16 v142, v9, s21, v147
    v_dot2_f32_bf16 v143, v13, s21, v147
    v_dot2_f32_bf16 v144, v17, s21, v147
    v_dot2_f32_bf16 v145, v21, s21, v147
    v_lshlrev_b32 v136, 16, v58
    v_and_b32 v137, 0xffff0000, v58
    v_dot2_f32_bf16 v128, v10, s20, v136
    v_cvt_pk_bf16_f32 v156, v138, v139
    v_dot2_f32_bf16 v129, v14, s20, v136
    v_cvt_pk_bf16_f32 v157, v140, v141
    v_dot2_f32_bf16 v130, v18, s20, v136
    v_cvt_pk_bf16_f32 v158, v142, v143
    v_dot2_f32_bf16 v131, v22, s20, v136
    v_cvt_pk_bf16_f32 v159, v144, v145
    v_mfma_f32_16x16x16_bf16 v[168:171], a[100:101], a[144:145], v[168:171]
    v_mfma_f32_16x16x16_bf16 v[172:175], a[102:103], a[144:145], v[172:175]
    ds_write_b128 v217, v[156:159] offset:1024
    v_dot2_f32_bf16 v132, v10, s21, v137
    v_dot2_f32_bf16 v133, v14, s21, v137
    v_dot2_f32_bf16 v134, v18, s21, v137
    v_dot2_f32_bf16 v135, v22, s21, v137
    v_lshlrev_b32 v146, 16, v59
    v_and_b32 v147, 0xffff0000, v59
    v_dot2_f32_bf16 v138, v11, s20, v146
    v_cvt_pk_bf16_f32 v152, v128, v129
    v_dot2_f32_bf16 v139, v15, s20, v146
    v_cvt_pk_bf16_f32 v153, v130, v131
    v_dot2_f32_bf16 v140, v19, s20, v146
    v_cvt_pk_bf16_f32 v154, v132, v133
    v_dot2_f32_bf16 v141, v23, s20, v146
    v_cvt_pk_bf16_f32 v155, v134, v135
    v_mfma_f32_16x16x16_bf16 v[176:179], a[104:105], a[144:145], v[176:179]
    v_mfma_f32_16x16x16_bf16 v[180:183], a[106:107], a[144:145], v[180:183]
    ds_write_b128 v217, v[152:155] offset:2048
    v_dot2_f32_bf16 v142, v11, s21, v147
    v_dot2_f32_bf16 v143, v15, s21, v147
    v_dot2_f32_bf16 v144, v19, s21, v147
    v_dot2_f32_bf16 v145, v23, s21, v147
    s_waitcnt vmcnt(5)
    v_lshlrev_b32 v136, 16, v60
    v_and_b32 v137, 0xffff0000, v60
    v_dot2_f32_bf16 v128, v24, s20, v136
    v_cvt_pk_bf16_f32 v156, v138, v139
    v_dot2_f32_bf16 v129, v28, s20, v136
    v_cvt_pk_bf16_f32 v157, v140, v141
    v_dot2_f32_bf16 v130, v32, s20, v136
    v_cvt_pk_bf16_f32 v158, v142, v143
    v_dot2_f32_bf16 v131, v36, s20, v136
    v_cvt_pk_bf16_f32 v159, v144, v145
    v_mfma_f32_16x16x16_bf16 v[160:163], a[108:109], a[146:147], v[160:163]
    v_mfma_f32_16x16x16_bf16 v[164:167], a[110:111], a[146:147], v[164:167]
    ds_write_b128 v217, v[156:159] offset:3072
    v_dot2_f32_bf16 v132, v24, s21, v137
    v_dot2_f32_bf16 v133, v28, s21, v137
    v_dot2_f32_bf16 v134, v32, s21, v137
    v_dot2_f32_bf16 v135, v36, s21, v137
    v_lshlrev_b32 v146, 16, v61
    v_and_b32 v147, 0xffff0000, v61
    v_dot2_f32_bf16 v138, v25, s20, v146
    v_cvt_pk_bf16_f32 v152, v128, v129
    v_dot2_f32_bf16 v139, v29, s20, v146
    v_cvt_pk_bf16_f32 v153, v130, v131
    v_dot2_f32_bf16 v140, v33, s20, v146
    v_cvt_pk_bf16_f32 v154, v132, v133
    v_dot2_f32_bf16 v141, v37, s20, v146
    v_cvt_pk_bf16_f32 v155, v134, v135
    v_mfma_f32_16x16x16_bf16 v[168:171], a[112:113], a[146:147], v[168:171]
    v_mfma_f32_16x16x16_bf16 v[172:175], a[114:115], a[146:147], v[172:175]
    ds_write_b128 v217, v[152:155] offset:4096
    v_dot2_f32_bf16 v142, v25, s21, v147
    v_dot2_f32_bf16 v143, v29, s21, v147
    v_dot2_f32_bf16 v144, v33, s21, v147
    v_dot2_f32_bf16 v145, v37, s21, v147
    v_lshlrev_b32 v136, 16, v62
    v_and_b32 v137, 0xffff0000, v62
    v_dot2_f32_bf16 v128, v26, s20, v136
    v_cvt_pk_bf16_f32 v156, v138, v139
    v_dot2_f32_bf16 v129, v30, s20, v136
    v_cvt_pk_bf16_f32 v157, v140, v141
    v_dot2_f32_bf16 v130, v34, s20, v136
    v_cvt_pk_bf16_f32 v158, v142, v143
    v_dot2_f32_bf16 v131, v38, s20, v136
    v_cvt_pk_bf16_f32 v159, v144, v145
    v_mfma_f32_16x16x16_bf16 v[176:179], a[116:117], a[146:147], v[176:179]
    v_mfma_f32_16x16x16_bf16 v[180:183], a[118:119], a[146:147], v[180:183]
    ds_write_b128 v217, v[156:159] offset:5120
    v_dot2_f32_bf16 v132, v26, s21, v137
    v_dot2_f32_bf16 v133, v30, s21, v137
    v_dot2_f32_bf16 v134, v34, s21, v137
    v_dot2_f32_bf16 v135, v38, s21, v137
    v_lshlrev_b32 v146, 16, v63
    v_and_b32 v147, 0xffff0000, v63
    v_dot2_f32_bf16 v138, v27, s20, v146
    v_cvt_pk_bf16_f32 v152, v128, v129
    v_dot2_f32_bf16 v139, v31, s20, v146
    v_cvt_pk_bf16_f32 v153, v130, v131
    v_dot2_f32_bf16 v140, v35, s20, v146
    v_cvt_pk_bf16_f32 v154, v132, v133
    v_dot2_f32_bf16 v141, v39, s20, v146
    v_cvt_pk_bf16_f32 v155, v134, v135
    v_mfma_f32_16x16x16_bf16 v[160:163], a[120:121], a[148:149], v[160:163]
    v_mfma_f32_16x16x16_bf16 v[164:167], a[122:123], a[148:149], v[164:167]
    ds_write_b128 v217, v[152:155] offset:6144
    v_dot2_f32_bf16 v142, v27, s21, v147
    v_dot2_f32_bf16 v143, v31, s21, v147
    v_dot2_f32_bf16 v144, v35, s21, v147
    v_dot2_f32_bf16 v145, v39, s21, v147
    s_waitcnt vmcnt(0)
    v_lshlrev_b32 v136, 16, v64
    v_and_b32 v137, 0xffff0000, v64
    v_dot2_f32_bf16 v128, v40, s20, v136
    v_cvt_pk_bf16_f32 v156, v138, v139
    v_dot2_f32_bf16 v129, v44, s20, v136
    v_cvt_pk_bf16_f32 v157, v140, v141
    v_dot2_f32_bf16 v130, v48, s20, v136
    v_cvt_pk_bf16_f32 v158, v142, v143
    v_dot2_f32_bf16 v131, v52, s20, v136
    v_cvt_pk_bf16_f32 v159, v144, v145
    v_mfma_f32_16x16x16_bf16 v[168:171], a[124:125], a[148:149], v[168:171]
    v_mfma_f32_16x16x16_bf16 v[172:175], a[126:127], a[148:149], v[172:175]
    ds_write_b128 v217, v[156:159] offset:7168
    v_dot2_f32_bf16 v132, v40, s21, v137
    v_dot2_f32_bf16 v133, v44, s21, v137
    v_dot2_f32_bf16 v134, v48, s21, v137
    v_dot2_f32_bf16 v135, v52, s21, v137
    v_lshlrev_b32 v146, 16, v65
    v_and_b32 v147, 0xffff0000, v65
    v_dot2_f32_bf16 v138, v41, s20, v146
    v_cvt_pk_bf16_f32 v152, v128, v129
    v_dot2_f32_bf16 v139, v45, s20, v146
    v_cvt_pk_bf16_f32 v153, v130, v131
    v_dot2_f32_bf16 v140, v49, s20, v146
    v_cvt_pk_bf16_f32 v154, v132, v133
    v_dot2_f32_bf16 v141, v53, s20, v146
    v_cvt_pk_bf16_f32 v155, v134, v135
    v_mfma_f32_16x16x16_bf16 v[176:179], a[128:129], a[148:149], v[176:179]
    v_mfma_f32_16x16x16_bf16 v[180:183], a[130:131], a[148:149], v[180:183]
    ds_write_b128 v217, v[152:155] offset:8192
    v_dot2_f32_bf16 v142, v41, s21, v147
    v_dot2_f32_bf16 v143, v45, s21, v147
    v_dot2_f32_bf16 v144, v49, s21, v147
    v_dot2_f32_bf16 v145, v53, s21, v147
    v_lshlrev_b32 v136, 16, v66
    v_and_b32 v137, 0xffff0000, v66
    v_dot2_f32_bf16 v128, v42, s20, v136
    v_cvt_pk_bf16_f32 v156, v138, v139
    v_dot2_f32_bf16 v129, v46, s20, v136
    v_cvt_pk_bf16_f32 v157, v140, v141
    v_dot2_f32_bf16 v130, v50, s20, v136
    v_cvt_pk_bf16_f32 v158, v142, v143
    v_dot2_f32_bf16 v131, v54, s20, v136
    v_cvt_pk_bf16_f32 v159, v144, v145
    v_mfma_f32_16x16x16_bf16 v[160:163], a[132:133], a[150:151], v[160:163]
    v_mfma_f32_16x16x16_bf16 v[164:167], a[134:135], a[150:151], v[164:167]
    ds_write_b128 v217, v[156:159] offset:9216
    v_dot2_f32_bf16 v132, v42, s21, v137
    v_dot2_f32_bf16 v133, v46, s21, v137
    v_dot2_f32_bf16 v134, v50, s21, v137
    v_dot2_f32_bf16 v135, v54, s21, v137
    v_lshlrev_b32 v146, 16, v67
    v_and_b32 v147, 0xffff0000, v67
    v_dot2_f32_bf16 v138, v43, s20, v146
    v_cvt_pk_bf16_f32 v152, v128, v129
    v_dot2_f32_bf16 v139, v47, s20, v146
    v_cvt_pk_bf16_f32 v153, v130, v131
    v_dot2_f32_bf16 v140, v51, s20, v146
    v_cvt_pk_bf16_f32 v154, v132, v133
    v_dot2_f32_bf16 v141, v55, s20, v146
    v_cvt_pk_bf16_f32 v155, v134, v135
    v_mfma_f32_16x16x16_bf16 v[168:171], a[136:137], a[150:151], v[168:171]
    v_mfma_f32_16x16x16_bf16 v[172:175], a[138:139], a[150:151], v[172:175]
    ds_write_b128 v217, v[152:155] offset:10240
    v_dot2_f32_bf16 v142, v43, s21, v147
    v_dot2_f32_bf16 v143, v47, s21, v147
    v_dot2_f32_bf16 v144, v51, s21, v147
    v_dot2_f32_bf16 v145, v55, s21, v147
    s_nop 0
    v_cvt_pk_bf16_f32 v156, v138, v139
    v_cvt_pk_bf16_f32 v157, v140, v141
    v_cvt_pk_bf16_f32 v158, v142, v143
    v_cvt_pk_bf16_f32 v159, v144, v145
    v_mfma_f32_16x16x16_bf16 v[176:179], a[140:141], a[150:151], v[176:179]
    v_mfma_f32_16x16x16_bf16 v[180:183], a[142:143], a[150:151], v[180:183]
    ds_write_b128 v217, v[156:159] offset:11264
    v_add_u32 v218, 98304, v210
    v_add_u32 v219, 98304, v211
    v_add_u32 v220, 98304, v212
    s_waitcnt lgkmcnt(0)
    s_barrier
    ds_read_b64_tr_b16 a[48:49], v218 offset:0
    ds_read_b64_tr_b16 a[50:51], v219 offset:0
    ds_read_b64_tr_b16 a[52:53], v218 offset:1024
    ds_read_b64_tr_b16 a[54:55], v219 offset:1024
    ds_read_b64_tr_b16 a[56:57], v218 offset:2048
    ds_read_b64_tr_b16 a[58:59], v219 offset:2048
    ds_read_b64_tr_b16 a[60:61], v218 offset:3072
    ds_read_b64_tr_b16 a[62:63], v219 offset:3072
    ds_read_b64_tr_b16 a[64:65], v218 offset:4096
    ds_read_b64_tr_b16 a[66:67], v219 offset:4096
    ds_read_b64_tr_b16 a[68:69], v218 offset:5120
    ds_read_b64_tr_b16 a[70:71], v219 offset:5120
    ds_read_b64_tr_b16 a[72:73], v218 offset:6144
    ds_read_b64_tr_b16 a[74:75], v219 offset:6144
    ds_read_b64_tr_b16 a[76:77], v218 offset:7168
    ds_read_b64_tr_b16 a[78:79], v219 offset:7168
    ds_read_b64_tr_b16 a[80:81], v218 offset:8192
    ds_read_b64_tr_b16 a[82:83], v219 offset:8192
    ds_read_b64_tr_b16 a[84:85], v218 offset:9216
    ds_read_b64_tr_b16 a[86:87], v219 offset:9216
    ds_read_b64_tr_b16 a[88:89], v218 offset:10240
    ds_read_b64_tr_b16 a[90:91], v219 offset:10240
    ds_read_b64_tr_b16 a[92:93], v218 offset:11264
    ds_read_b64_tr_b16 a[94:95], v219 offset:11264
    s_waitcnt lgkmcnt(15)
    v_mfma_f32_16x16x32_bf16 v[192:195], a[48:51], a[48:51], 0
    ds_read_b128 a[96:99], v220 offset:0
    v_mfma_f32_16x16x32_bf16 v[192:195], a[52:55], a[52:55], v[192:195]
    ds_read_b128 a[100:103], v220 offset:4096
    v_mfma_f32_16x16x32_bf16 v[192:195], a[56:59], a[56:59], v[192:195]
    ds_read_b128 a[104:107], v220 offset:8192
    s_waitcnt lgkmcnt(15)
    v_mfma_f32_16x16x32_bf16 v[192:195], a[60:63], a[60:63], v[192:195]
    ds_read_b128 a[108:111], v220 offset:12288
    v_mfma_f32_16x16x32_bf16 v[192:195], a[64:67], a[64:67], v[192:195]
    ds_read_b128 a[112:115], v220 offset:16384
    v_mfma_f32_16x16x32_bf16 v[192:195], a[68:71], a[68:71], v[192:195]
    ds_read_b128 a[116:119], v220 offset:20480
    s_waitcnt lgkmcnt(12)
    v_mfma_f32_16x16x32_bf16 v[192:195], a[72:75], a[72:75], v[192:195]
    ds_read_b128 a[120:123], v220 offset:24576
    v_mfma_f32_16x16x32_bf16 v[192:195], a[76:79], a[76:79], v[192:195]
    ds_read_b128 a[124:127], v220 offset:28672
    v_mfma_f32_16x16x32_bf16 v[192:195], a[80:83], a[80:83], v[192:195]
    ds_read_b128 a[128:131], v220 offset:32768
    s_waitcnt lgkmcnt(9)
    v_mfma_f32_16x16x32_bf16 v[192:195], a[84:87], a[84:87], v[192:195]
    ds_read_b128 a[132:135], v220 offset:36864
    v_mfma_f32_16x16x32_bf16 v[192:195], a[88:91], a[88:91], v[192:195]
    ds_read_b128 a[136:139], v220 offset:40960
    v_mfma_f32_16x16x32_bf16 v[192:195], a[92:95], a[92:95], v[192:195]
    ds_read_b128 a[140:143], v220 offset:45056
    v_mfma_f32_16x16x32_bf16 v[188:191], a[48:51], a[152:155], 0
    v_mfma_f32_16x16x32_bf16 v[188:191], a[52:55], a[152:155], v[188:191]
    v_mfma_f32_16x16x32_bf16 v[188:191], a[56:59], a[152:155], v[188:191]
    v_mfma_f32_16x16x32_bf16 v[188:191], a[60:63], a[152:155], v[188:191]
    v_mfma_f32_16x16x32_bf16 v[188:191], a[64:67], a[152:155], v[188:191]
    v_mfma_f32_16x16x32_bf16 v[188:191], a[68:71], a[152:155], v[188:191]
    v_mfma_f32_16x16x32_bf16 v[188:191], a[72:75], a[152:155], v[188:191]
    v_mfma_f32_16x16x32_bf16 v[188:191], a[76:79], a[152:155], v[188:191]
    v_cndmask_b32 v128, 0, v192, s[26:27]
    v_mfma_f32_16x16x32_bf16 v[188:191], a[80:83], a[152:155], v[188:191]
    v_cndmask_b32 v128, v128, v193, s[28:29]
    v_mfma_f32_16x16x32_bf16 v[188:191], a[84:87], a[152:155], v[188:191]
    v_cndmask_b32 v128, v128, v194, s[30:31]
    v_mfma_f32_16x16x32_bf16 v[188:191], a[88:91], a[152:155], v[188:191]
    v_cndmask_b32 v128, v128, v195, s[32:33]
    v_mfma_f32_16x16x32_bf16 v[188:191], a[92:95], a[152:155], v[188:191]
    v_mfma_f32_16x16x32_bf16 v[184:187], a[48:51], a[0:3], 0
    v_mfma_f32_16x16x4_f32 v[196:199], v128, v205, 0
    v_mfma_f32_16x16x32_bf16 v[184:187], a[52:55], a[4:7], v[184:187]
    v_mfma_f32_16x16x32_bf16 v[184:187], a[56:59], a[8:11], v[184:187]
    v_mfma_f32_16x16x32_bf16 v[184:187], a[60:63], a[12:15], v[184:187]
    v_mfma_f32_16x16x32_bf16 v[184:187], a[64:67], a[16:19], v[184:187]
    v_mfma_f32_16x16x32_bf16 v[184:187], a[68:71], a[20:23], v[184:187]
    v_mfma_f32_16x16x32_bf16 v[184:187], a[72:75], a[24:27], v[184:187]
    v_mul_f32 v188, s23, v188
    v_mfma_f32_16x16x32_bf16 v[184:187], a[76:79], a[28:31], v[184:187]
    v_mul_f32 v189, s23, v189
    v_mfma_f32_16x16x32_bf16 v[184:187], a[80:83], a[32:35], v[184:187]
    v_mul_f32 v190, s23, v190
    v_mfma_f32_16x16x32_bf16 v[184:187], a[84:87], a[36:39], v[184:187]
    v_mul_f32 v191, s23, v191
    v_mfma_f32_16x16x32_bf16 v[184:187], a[88:91], a[40:43], v[184:187]
    v_fma_f32 v128, -v188, v188, v206
    v_fma_f32 v129, -v189, v189, v206
    v_mfma_f32_16x16x32_bf16 v[184:187], a[92:95], a[44:47], v[184:187]
    v_fma_f32 v130, -v190, v190, v206
    v_fma_f32 v131, -v191, v191, v206
    v_fma_f32 v196, v196, s23, v128
    v_fma_f32 v197, v197, s23, v129
    v_fma_f32 v198, v198, s23, v130
    v_fma_f32 v199, v199, s23, v131
    v_rsq_f32 v196, v196
    v_rsq_f32 v197, v197
    v_rsq_f32 v198, v198
    v_rsq_f32 v199, v199
    v_pk_fma_f32 v[184:185], v[188:189], v[204:205], v[184:185] op_sel_hi:[1,0,1] neg_lo:[1,0,0] neg_hi:[1,0,0]
    v_pk_fma_f32 v[186:187], v[190:191], v[204:205], v[186:187] op_sel_hi:[1,0,1] neg_lo:[1,0,0] neg_hi:[1,0,0]
    v_pk_fma_f32 v[136:137], v[184:185], v[196:197], v[202:203] op_sel_hi:[1,1,0] neg_lo:[0,0,1] neg_hi:[0,0,1]
    v_pk_fma_f32 v[138:139], v[186:187], v[198:199], v[202:203] op_sel_hi:[1,1,0] neg_lo:[0,0,1] neg_hi:[0,0,1]
    v_max3_f32 v128, v136, v137, v138
    v_max_f32 v128, v128, v139
    v_cmp_lt_f32 vcc, s61, v128
    v_exp_f32 v136, v136
    v_exp_f32 v137, v137
    v_exp_f32 v138, v138
    v_exp_f32 v139, v139
    s_nop 0
    v_pk_mul_f32 v[132:133], v[136:137], v[196:197]
    v_pk_mul_f32 v[134:135], v[138:139], v[198:199]
    v_cvt_pk_bf16_f32 v200, v132, v133
    v_cvt_pk_bf16_f32 v201, v134, v135
    ds_write_b64 v213, v[200:201] offset:12288
    v_cndmask_b32 v128, 0, 1, vcc
    ds_write_b32 v254, v128 offset:10816
    v_add_f32 v136, v136, v137
    v_add_f32 v138, v138, v139
    v_lshlrev_b32 v132, 16, v200
    v_and_b32 v133, 0xffff0000, v200
    v_lshlrev_b32 v134, 16, v201
    v_and_b32 v135, 0xffff0000, v201
    v_add_f32 v140, v136, v138
    v_mul_f32 v141, v132, v188
    v_mul_f32 v132, v133, v189
    v_fmac_f32 v141, v134, v190
    v_fmac_f32 v132, v135, v191
    v_add_f32 v141, v141, v132
    s_waitcnt lgkmcnt(0)
    s_barrier
    ds_read_b128 v[128:131], v255 offset:10816
    ds_read_b64 a[144:145], v214 offset:12288
    ds_read_b64 a[146:147], v214 offset:12800
    ds_read_b64 a[148:149], v214 offset:13312
    ds_read_b64 a[150:151], v214 offset:13824
    s_waitcnt lgkmcnt(4)
    v_or3_b32 v128, v128, v129, v130
    v_or_b32 v128, v128, v131
    v_cmp_ne_u32 vcc, 0, v128
    s_cbranch_vccz BJ_39
    v_mul_f32 v136, v184, v196
    v_mul_f32 v137, v185, v197
    v_mul_f32 v138, v186, v198
    v_mul_f32 v139, v187, v199
    v_max3_f32 v128, v136, v137, v138
    v_max_f32 v128, v128, v139
    ds_max_f32 v215, v128
    s_waitcnt lgkmcnt(0)
    s_barrier
    ds_read_b32 v129, v215
    s_waitcnt lgkmcnt(0)
    v_sub_f32 v130, v202, v129
    v_sub_f32 v136, v136, v129
    v_sub_f32 v137, v137, v129
    v_sub_f32 v138, v138, v129
    v_sub_f32 v139, v139, v129
    v_exp_f32 v130, v130
    v_mov_b32 v202, v129
    v_exp_f32 v136, v136
    v_exp_f32 v137, v137
    v_exp_f32 v138, v138
    v_exp_f32 v139, v139
    s_nop 0
    v_pk_mul_f32 v[132:133], v[136:137], v[196:197]
    v_pk_mul_f32 v[134:135], v[138:139], v[198:199]
    v_cvt_pk_bf16_f32 v200, v132, v133
    v_cvt_pk_bf16_f32 v201, v134, v135
    ds_write_b64 v213, v[200:201] offset:12288
    v_mul_f32 v203, v203, v130
    v_mul_f32 v221, v221, v130
    v_pk_mul_f32 v[160:161], v[160:161], v[130:131] op_sel_hi:[1,0]
    v_pk_mul_f32 v[162:163], v[162:163], v[130:131] op_sel_hi:[1,0]
    v_pk_mul_f32 v[164:165], v[164:165], v[130:131] op_sel_hi:[1,0]
    v_pk_mul_f32 v[166:167], v[166:167], v[130:131] op_sel_hi:[1,0]
    v_pk_mul_f32 v[168:169], v[168:169], v[130:131] op_sel_hi:[1,0]
    v_pk_mul_f32 v[170:171], v[170:171], v[130:131] op_sel_hi:[1,0]
    v_pk_mul_f32 v[172:173], v[172:173], v[130:131] op_sel_hi:[1,0]
    v_pk_mul_f32 v[174:175], v[174:175], v[130:131] op_sel_hi:[1,0]
    v_pk_mul_f32 v[176:177], v[176:177], v[130:131] op_sel_hi:[1,0]
    v_pk_mul_f32 v[178:179], v[178:179], v[130:131] op_sel_hi:[1,0]
    v_pk_mul_f32 v[180:181], v[180:181], v[130:131] op_sel_hi:[1,0]
    v_pk_mul_f32 v[182:183], v[182:183], v[130:131] op_sel_hi:[1,0]
    v_add_f32 v136, v136, v137
    v_add_f32 v138, v138, v139
    v_lshlrev_b32 v132, 16, v200
    v_and_b32 v133, 0xffff0000, v200
    v_lshlrev_b32 v134, 16, v201
    v_and_b32 v135, 0xffff0000, v201
    v_add_f32 v140, v136, v138
    v_mul_f32 v141, v132, v188
    v_mul_f32 v132, v133, v189
    v_fmac_f32 v141, v134, v190
    v_fmac_f32 v132, v135, v191
    v_add_f32 v141, v141, v132
    s_waitcnt lgkmcnt(0)
    s_barrier
    ds_read_b64 a[144:145], v214 offset:12288
    ds_read_b64 a[146:147], v214 offset:12800
    ds_read_b64 a[148:149], v214 offset:13312
    ds_read_b64 a[150:151], v214 offset:13824
BJ_39:
    v_add_f32 v203, v203, v140
    v_add_f32 v221, v221, v141
    v_mov_b32 v128, v203
    v_mov_b32 v129, v221
    s_nop 0
    v_permlane32_swap_b32 v128, v203
    v_permlane32_swap_b32 v129, v221
    v_add_f32 v203, v203, v128
    v_add_f32 v221, v221, v129
    v_mov_b32 v128, v203
    v_mov_b32 v129, v221
    s_nop 0
    v_permlane16_swap_b32 v128, v203
    v_permlane16_swap_b32 v129, v221
    v_add_f32 v203, v203, v128
    v_add_f32 v221, v221, v129
    ds_write_b32 v2, v203
    ds_write_b32 v2, v221 offset:256
    v_mov_b32 v11, s50
    v_mov_b32 v15, s50
    v_mov_b32 v19, s50
    v_mov_b32 v23, s50
    s_waitcnt lgkmcnt(0)
    v_mfma_f32_16x16x16_bf16 v[160:163], a[96:97], a[144:145], v[160:163]
    v_mfma_f32_16x16x16_bf16 v[164:167], a[98:99], a[144:145], v[164:167]
    v_mfma_f32_16x16x16_bf16 v[168:171], a[100:101], a[144:145], v[168:171]
    v_mfma_f32_16x16x16_bf16 v[172:175], a[102:103], a[144:145], v[172:175]
    v_mfma_f32_16x16x16_bf16 v[176:179], a[104:105], a[144:145], v[176:179]
    v_mfma_f32_16x16x16_bf16 v[180:183], a[106:107], a[144:145], v[180:183]
    v_mfma_f32_16x16x16_bf16 v[160:163], a[108:109], a[146:147], v[160:163]
    v_mfma_f32_16x16x16_bf16 v[164:167], a[110:111], a[146:147], v[164:167]
    v_mfma_f32_16x16x16_bf16 v[168:171], a[112:113], a[146:147], v[168:171]
    v_mfma_f32_16x16x16_bf16 v[172:175], a[114:115], a[146:147], v[172:175]
    v_mfma_f32_16x16x16_bf16 v[176:179], a[116:117], a[146:147], v[176:179]
    v_mfma_f32_16x16x16_bf16 v[180:183], a[118:119], a[146:147], v[180:183]
    v_mfma_f32_16x16x16_bf16 v[160:163], a[120:121], a[148:149], v[160:163]
    v_mfma_f32_16x16x16_bf16 v[164:167], a[122:123], a[148:149], v[164:167]
    v_mfma_f32_16x16x16_bf16 v[168:171], a[124:125], a[148:149], v[168:171]
    v_mfma_f32_16x16x16_bf16 v[172:175], a[126:127], a[148:149], v[172:175]
    v_mfma_f32_16x16x16_bf16 v[176:179], a[128:129], a[148:149], v[176:179]
    v_mfma_f32_16x16x16_bf16 v[180:183], a[130:131], a[148:149], v[180:183]
    v_mfma_f32_16x16x16_bf16 v[160:163], a[132:133], a[150:151], v[160:163]
    v_mfma_f32_16x16x16_bf16 v[164:167], a[134:135], a[150:151], v[164:167]
    v_mfma_f32_16x16x16_bf16 v[168:171], a[136:137], a[150:151], v[168:171]
    v_mfma_f32_16x16x16_bf16 v[172:175], a[138:139], a[150:151], v[172:175]
    v_mfma_f32_16x16x16_bf16 v[176:179], a[140:141], a[150:151], v[176:179]
    v_mfma_f32_16x16x16_bf16 v[180:183], a[142:143], a[150:151], v[180:183]
MEND_17:
    s_barrier
    s_cmp_eq_u32 s16, 0
    s_cbranch_scc0 EP0_41
    ds_read_b128 v[40:43], v7
    ds_read_b128 v[44:47], v7 offset:256
    v_mov_b32 v48, v202
    v_mov_b32 v51, s50
EP0_41:
    s_nop 3
    v_cvt_pk_bf16_f32 v8, v160, v164
    v_cvt_pk_bf16_f32 v9, v168, v172
    v_cvt_pk_bf16_f32 v10, v176, v180
    ds_write_b128 v3, v[8:11] offset:0
    v_cvt_pk_bf16_f32 v12, v161, v165
    v_cvt_pk_bf16_f32 v13, v169, v173
    v_cvt_pk_bf16_f32 v14, v177, v181
    ds_write_b128 v3, v[12:15] offset:16
    v_cvt_pk_bf16_f32 v16, v162, v166
    v_cvt_pk_bf16_f32 v17, v170, v174
    v_cvt_pk_bf16_f32 v18, v178, v182
    ds_write_b128 v3, v[16:19] offset:32
    v_cvt_pk_bf16_f32 v20, v163, v167
    v_cvt_pk_bf16_f32 v21, v171, v175
    v_cvt_pk_bf16_f32 v22, v179, v183
    ds_write_b128 v3, v[20:23] offset:48
    ds_read_b128 v[24:27], v4 offset:0
    ds_read_b128 v[28:31], v4 offset:1088
    ds_read_b128 v[32:35], v4 offset:2176
    ds_read_b128 v[36:39], v4 offset:3264
    s_waitcnt lgkmcnt(3)
    global_store_dwordx4 v5, v[24:27], s[8:9] sc1
    s_waitcnt lgkmcnt(2)
    global_store_dwordx4 v5, v[28:31], s[76:77] sc1
    s_waitcnt lgkmcnt(1)
    global_store_dwordx4 v5, v[32:35], s[78:79] sc1
    s_waitcnt lgkmcnt(0)
    global_store_dwordx4 v5, v[36:39], s[80:81] sc1
    s_cmp_eq_u32 s16, 0
    s_cbranch_scc0 EP_40
    v_add_f32 v40, v40, v41
    v_add_f32 v42, v42, v43
    v_add_f32 v44, v44, v45
    v_add_f32 v46, v46, v47
    v_add_f32 v49, v40, v42
    v_add_f32 v50, v44, v46
    v_cmp_gt_u32 vcc, 16, v216
    s_and_saveexec_b64 s[62:63], vcc
    global_store_dwordx4 v6, v[48:51], s[8:9] sc1
    s_mov_b64 exec, s[62:63]
EP_40:
    s_cmp_eq_u32 s52, 5
    s_cbranch_scc0 TR_42
    s_and_b32 s34, s53, 15
    s_lshr_b32 s35, s53, 4
    s_lshl_b32 s36, s34, 4
    s_lshl_b32 s37, s16, 14
    s_add_u32 s36, s36, s37
    s_add_u32 s36, s36, 131072
    v_lshlrev_b32 v1, 8, v216
    v_add_u32 v1, s36, v1
    s_lshl_b32 s36, s34, 3
    s_add_u32 s36, s36, s35
    s_lshl_b32 s36, s36, 15
    s_lshl_b32 s37, s16, 13
    s_add_u32 s36, s36, s37
    s_add_u32 s36, s36, 1052672
    v_add_u32 v2, s36, v223
RL_44:
    global_load_dwordx4 v[8:11], v1, s[8:9] sc1
    s_waitcnt vmcnt(0)
    v_cmp_ne_u32 vcc, s50, v11
    s_cbranch_vccz RO_45
    s_add_u32 s60, s60, 1
    s_cmp_lt_u32 s60, 65536
    s_cbranch_scc0 K_END
    s_branch RL_44
RO_45:
    global_load_dwordx4 v[16:19], v2, s[8:9] offset:-4096 sc1
    global_load_dwordx4 v[20:23], v2, s[8:9] offset:-3072 sc1
    global_load_dwordx4 v[24:27], v2, s[8:9] offset:-2048 sc1
    global_load_dwordx4 v[28:31], v2, s[8:9] offset:-1024 sc1
    global_load_dwordx4 v[32:35], v2, s[8:9] offset:0 sc1
    global_load_dwordx4 v[36:39], v2, s[8:9] offset:1024 sc1
    global_load_dwordx4 v[40:43], v2, s[8:9] offset:2048 sc1
    global_load_dwordx4 v[44:47], v2, s[8:9] offset:3072 sc1
    v_mov_b32 v12, v8
    s_nop 1
    v_max_f32_dpp v12, v12, v12 row_ror:8 row_mask:0xf bank_mask:0xf
    s_nop 1
    v_max_f32_dpp v12, v12, v12 row_ror:4 row_mask:0xf bank_mask:0xf
    s_nop 1
    v_max_f32_dpp v12, v12, v12 row_ror:2 row_mask:0xf bank_mask:0xf
    s_nop 1
    v_max_f32_dpp v12, v12, v12 row_ror:1 row_mask:0xf bank_mask:0xf
    v_mov_b32 v13, v12
    s_nop 1
    v_permlane32_swap_b32 v13, v12
    v_max_f32 v12, v12, v13
    v_mov_b32 v13, v12
    s_nop 1
    v_permlane16_swap_b32 v13, v12
    v_max_f32 v12, v12, v13
    v_sub_f32 v8, v8, v12
    v_exp_f32 v8, v8
    v_lshrrev_b32 v3, 3, v216
    v_lshlrev_b32 v3, 2, v3
    v_mul_f32 v9, v9, v8
    v_mul_f32 v10, v10, v8
    v_add_u32 v4, 0, v3
    ds_bpermute_b32 v48, v4, v8
    v_add_u32 v4, 32, v3
    ds_bpermute_b32 v49, v4, v8
    v_add_u32 v4, 64, v3
    ds_bpermute_b32 v50, v4, v8
    v_add_u32 v4, 96, v3
    ds_bpermute_b32 v51, v4, v8
    v_add_u32 v4, 128, v3
    ds_bpermute_b32 v52, v4, v8
    v_add_u32 v4, 160, v3
    ds_bpermute_b32 v53, v4, v8
    v_add_u32 v4, 192, v3
    ds_bpermute_b32 v54, v4, v8
    v_add_u32 v4, 224, v3
    ds_bpermute_b32 v55, v4, v8
    s_nop 0
    v_add_f32_dpp v9, v9, v9 row_ror:8 row_mask:0xf bank_mask:0xf
    v_add_f32_dpp v10, v10, v10 row_ror:8 row_mask:0xf bank_mask:0xf
    s_nop 0
    v_add_f32_dpp v9, v9, v9 row_ror:4 row_mask:0xf bank_mask:0xf
    v_add_f32_dpp v10, v10, v10 row_ror:4 row_mask:0xf bank_mask:0xf
    s_nop 0
    v_add_f32_dpp v9, v9, v9 row_ror:2 row_mask:0xf bank_mask:0xf
    v_add_f32_dpp v10, v10, v10 row_ror:2 row_mask:0xf bank_mask:0xf
    s_nop 0
    v_add_f32_dpp v9, v9, v9 row_ror:1 row_mask:0xf bank_mask:0xf
    v_add_f32_dpp v10, v10, v10 row_ror:1 row_mask:0xf bank_mask:0xf
    v_mov_b32 v13, v9
    v_mov_b32 v14, v10
    s_nop 0
    v_permlane32_swap_b32 v13, v9
    v_permlane32_swap_b32 v14, v10
    v_add_f32 v9, v9, v13
    v_add_f32 v10, v10, v14
    v_mov_b32 v13, v9
    v_mov_b32 v14, v10
    s_nop 0
    v_permlane16_swap_b32 v13, v9
    v_permlane16_swap_b32 v14, v10
    v_add_f32 v9, v9, v13
    v_add_f32 v10, v10, v14
    v_mov_b32 v56, 0
    v_mov_b32 v57, 0
    v_mov_b32 v58, 0
    v_mov_b32 v59, 0
    v_mov_b32 v60, 0
    v_mov_b32 v61, 0
RD_46:
    s_waitcnt vmcnt(0)
    v_xor_b32 v64, s50, v19
    v_xor_b32 v65, s50, v23
    v_xor_b32 v66, s50, v27
    v_xor_b32 v67, s50, v31
    v_xor_b32 v68, s50, v35
    v_xor_b32 v69, s50, v39
    v_xor_b32 v70, s50, v43
    v_xor_b32 v71, s50, v47
    v_or3_b32 v64, v64, v65, v66
    v_or3_b32 v67, v67, v68, v69
    v_or3_b32 v64, v64, v70, v71
    v_or_b32 v64, v64, v67
    v_cmp_ne_u32 vcc, 0, v64
    s_cbranch_vccz RO2_47
    s_add_u32 s60, s60, 1
    s_cmp_lt_u32 s60, 65536
    s_cbranch_scc0 K_END
    global_load_dwordx4 v[16:19], v2, s[8:9] offset:-4096 sc1
    global_load_dwordx4 v[20:23], v2, s[8:9] offset:-3072 sc1
    global_load_dwordx4 v[24:27], v2, s[8:9] offset:-2048 sc1
    global_load_dwordx4 v[28:31], v2, s[8:9] offset:-1024 sc1
    global_load_dwordx4 v[32:35], v2, s[8:9] offset:0 sc1
    global_load_dwordx4 v[36:39], v2, s[8:9] offset:1024 sc1
    global_load_dwordx4 v[40:43], v2, s[8:9] offset:2048 sc1
    global_load_dwordx4 v[44:47], v2, s[8:9] offset:3072 sc1
    s_branch RD_46
RO2_47:
    s_waitcnt lgkmcnt(0)
    v_lshlrev_b32 v64, 16, v16
    v_and_b32 v65, 0xffff0000, v16
    v_fmac_f32 v56, v64, v48
    v_fmac_f32 v57, v65, v48
    v_lshlrev_b32 v64, 16, v17
    v_and_b32 v65, 0xffff0000, v17
    v_fmac_f32 v58, v64, v48
    v_fmac_f32 v59, v65, v48
    v_lshlrev_b32 v64, 16, v18
    v_and_b32 v65, 0xffff0000, v18
    v_fmac_f32 v60, v64, v48
    v_fmac_f32 v61, v65, v48
    v_lshlrev_b32 v64, 16, v20
    v_and_b32 v65, 0xffff0000, v20
    v_fmac_f32 v56, v64, v49
    v_fmac_f32 v57, v65, v49
    v_lshlrev_b32 v64, 16, v21
    v_and_b32 v65, 0xffff0000, v21
    v_fmac_f32 v58, v64, v49
    v_fmac_f32 v59, v65, v49
    v_lshlrev_b32 v64, 16, v22
    v_and_b32 v65, 0xffff0000, v22
    v_fmac_f32 v60, v64, v49
    v_fmac_f32 v61, v65, v49
    v_lshlrev_b32 v64, 16, v24
    v_and_b32 v65, 0xffff0000, v24
    v_fmac_f32 v56, v64, v50
    v_fmac_f32 v57, v65, v50
    v_lshlrev_b32 v64, 16, v25
    v_and_b32 v65, 0xffff0000, v25
    v_fmac_f32 v58, v64, v50
    v_fmac_f32 v59, v65, v50
    v_lshlrev_b32 v64, 16, v26
    v_and_b32 v65, 0xffff0000, v26
    v_fmac_f32 v60, v64, v50
    v_fmac_f32 v61, v65, v50
    v_lshlrev_b32 v64, 16, v28
    v_and_b32 v65, 0xffff0000, v28
    v_fmac_f32 v56, v64, v51
    v_fmac_f32 v57, v65, v51
    v_lshlrev_b32 v64, 16, v29
    v_and_b32 v65, 0xffff0000, v29
    v_fmac_f32 v58, v64, v51
    v_fmac_f32 v59, v65, v51
    v_lshlrev_b32 v64, 16, v30
    v_and_b32 v65, 0xffff0000, v30
    v_fmac_f32 v60, v64, v51
    v_fmac_f32 v61, v65, v51
    v_lshlrev_b32 v64, 16, v32
    v_and_b32 v65, 0xffff0000, v32
    v_fmac_f32 v56, v64, v52
    v_fmac_f32 v57, v65, v52
    v_lshlrev_b32 v64, 16, v33
    v_and_b32 v65, 0xffff0000, v33
    v_fmac_f32 v58, v64, v52
    v_fmac_f32 v59, v65, v52
    v_lshlrev_b32 v64, 16, v34
    v_and_b32 v65, 0xffff0000, v34
    v_fmac_f32 v60, v64, v52
    v_fmac_f32 v61, v65, v52
    v_lshlrev_b32 v64, 16, v36
    v_and_b32 v65, 0xffff0000, v36
    v_fmac_f32 v56, v64, v53
    v_fmac_f32 v57, v65, v53
    v_lshlrev_b32 v64, 16, v37
    v_and_b32 v65, 0xffff0000, v37
    v_fmac_f32 v58, v64, v53
    v_fmac_f32 v59, v65, v53
    v_lshlrev_b32 v64, 16, v38
    v_and_b32 v65, 0xffff0000, v38
    v_fmac_f32 v60, v64, v53
    v_fmac_f32 v61, v65, v53
    v_lshlrev_b32 v64, 16, v40
    v_and_b32 v65, 0xffff0000, v40
    v_fmac_f32 v56, v64, v54
    v_fmac_f32 v57, v65, v54
    v_lshlrev_b32 v64, 16, v41
    v_and_b32 v65, 0xffff0000, v41
    v_fmac_f32 v58, v64, v54
    v_fmac_f32 v59, v65, v54
    v_lshlrev_b32 v64, 16, v42
    v_and_b32 v65, 0xffff0000, v42
    v_fmac_f32 v60, v64, v54
    v_fmac_f32 v61, v65, v54
    v_lshlrev_b32 v64, 16, v44
    v_and_b32 v65, 0xffff0000, v44
    v_fmac_f32 v56, v64, v55
    v_fmac_f32 v57, v65, v55
    v_lshlrev_b32 v64, 16, v45
    v_and_b32 v65, 0xffff0000, v45
    v_fmac_f32 v58, v64, v55
    v_fmac_f32 v59, v65, v55
    v_lshlrev_b32 v64, 16, v46
    v_and_b32 v65, 0xffff0000, v46
    v_fmac_f32 v60, v64, v55
    v_fmac_f32 v61, v65, v55
    v_add_f32_dpp v56, v56, v56 row_ror:8 row_mask:0xf bank_mask:0xf
    v_add_f32_dpp v57, v57, v57 row_ror:8 row_mask:0xf bank_mask:0xf
    v_add_f32_dpp v58, v58, v58 row_ror:8 row_mask:0xf bank_mask:0xf
    v_add_f32_dpp v59, v59, v59 row_ror:8 row_mask:0xf bank_mask:0xf
    v_add_f32_dpp v60, v60, v60 row_ror:8 row_mask:0xf bank_mask:0xf
    v_add_f32_dpp v61, v61, v61 row_ror:8 row_mask:0xf bank_mask:0xf
    v_mov_b32 v64, v56
    v_mov_b32 v65, v57
    v_mov_b32 v66, v58
    v_mov_b32 v67, v59
    v_mov_b32 v68, v60
    v_mov_b32 v69, v61
    v_permlane32_swap_b32 v64, v56
    v_permlane32_swap_b32 v65, v57
    v_permlane32_swap_b32 v66, v58
    v_permlane32_swap_b32 v67, v59
    v_permlane32_swap_b32 v68, v60
    v_permlane32_swap_b32 v69, v61
    v_add_f32 v56, v56, v64
    v_add_f32 v57, v57, v65
    v_add_f32 v58, v58, v66
    v_add_f32 v59, v59, v67
    v_add_f32 v60, v60, v68
    v_add_f32 v61, v61, v69
    v_mov_b32 v64, v56
    v_mov_b32 v65, v57
    v_mov_b32 v66, v58
    v_mov_b32 v67, v59
    v_mov_b32 v68, v60
    v_mov_b32 v69, v61
    v_permlane16_swap_b32 v64, v56
    v_permlane16_swap_b32 v65, v57
    v_permlane16_swap_b32 v66, v58
    v_permlane16_swap_b32 v67, v59
    v_permlane16_swap_b32 v68, v60
    v_permlane16_swap_b32 v69, v61
    v_add_f32 v56, v56, v64
    v_add_f32 v57, v57, v65
    v_add_f32 v58, v58, v66
    v_add_f32 v59, v59, v67
    v_add_f32 v60, v60, v68
    v_add_f32 v61, v61, v69
    s_lshl_b32 s36, s16, 8
    s_add_u32 s36, s36, 0
    v_mul_u32_u24 v3, 24, v216
    v_add_u32 v3, s36, v3
    v_mov_b32 v4, s36
    v_mov_b32 v13, v9
    v_mov_b32 v14, v10
    v_mov_b32 v15, 0
    v_cmp_gt_u32 vcc, 8, v216
    s_and_saveexec_b64 s[62:63], vcc
    ds_write_b64 v3, v[56:57]
    ds_write_b64 v3, v[58:59] offset:8
    ds_write_b64 v3, v[60:61] offset:16
    ds_write_b128 v4, v[12:15] offset:192
    s_mov_b64 exec, s[62:63]
    s_waitcnt lgkmcnt(0)
    s_barrier
    s_cmp_eq_u32 s16, 0
    s_cbranch_scc0 RF_48
    v_min_u32 v3, 7, v216
    v_mul_u32_u24 v3, 24, v3
    v_add_u32 v3, 0, v3
    v_mov_b32 v4, 0
    ds_read_b128 v[16:19], v4 offset:192
    ds_read_b128 v[20:23], v4 offset:448
    ds_read_b128 v[24:27], v4 offset:704
    ds_read_b128 v[28:31], v4 offset:960
    ds_read_b64 v[32:33], v3 offset:0
    ds_read_b64 v[34:35], v3 offset:8
    ds_read_b64 v[36:37], v3 offset:16
    ds_read_b64 v[38:39], v3 offset:256
    ds_read_b64 v[40:41], v3 offset:264
    ds_read_b64 v[42:43], v3 offset:272
    ds_read_b64 v[44:45], v3 offset:512
    ds_read_b64 v[46:47], v3 offset:520
    ds_read_b64 v[48:49], v3 offset:528
    ds_read_b64 v[50:51], v3 offset:768
    ds_read_b64 v[52:53], v3 offset:776
    ds_read_b64 v[54:55], v3 offset:784
    s_waitcnt lgkmcnt(12)
    v_max_f32 v12, v16, v20
    v_max3_f32 v12, v12, v24, v28
    v_sub_f32 v16, v16, v12
    v_sub_f32 v20, v20, v12
    v_sub_f32 v24, v24, v12
    v_sub_f32 v28, v28, v12
    v_exp_f32 v16, v16
    v_exp_f32 v20, v20
    v_exp_f32 v24, v24
    v_exp_f32 v28, v28
    s_nop 0
    v_mul_f32 v13, v16, v17
    v_mul_f32 v14, v16, v18
    v_fmac_f32 v13, v20, v21
    v_fmac_f32 v14, v20, v22
    v_fmac_f32 v13, v24, v25
    v_fmac_f32 v14, v24, v26
    v_fmac_f32 v13, v28, v29
    v_fmac_f32 v14, v28, v30
    v_rcp_f32 v13, v13
    s_waitcnt lgkmcnt(0)
    v_mul_f32 v56, v32, v16
    v_mul_f32 v57, v33, v16
    v_mul_f32 v58, v34, v16
    v_mul_f32 v59, v35, v16
    v_mul_f32 v60, v36, v16
    v_mul_f32 v61, v37, v16
    v_fmac_f32 v56, v38, v20
    v_fmac_f32 v57, v39, v20
    v_fmac_f32 v58, v40, v20
    v_fmac_f32 v59, v41, v20
    v_fmac_f32 v60, v42, v20
    v_fmac_f32 v61, v43, v20
    v_fmac_f32 v56, v44, v24
    v_fmac_f32 v57, v45, v24
    v_fmac_f32 v58, v46, v24
    v_fmac_f32 v59, v47, v24
    v_fmac_f32 v60, v48, v24
    v_fmac_f32 v61, v49, v24
    v_fmac_f32 v56, v50, v28
    v_fmac_f32 v57, v51, v28
    v_fmac_f32 v58, v52, v28
    v_fmac_f32 v59, v53, v28
    v_fmac_f32 v60, v54, v28
    v_fmac_f32 v61, v55, v28
    v_sub_f32 v56, v56, v14
    v_sub_f32 v57, v57, v14
    v_sub_f32 v58, v58, v14
    v_sub_f32 v59, v59, v14
    v_sub_f32 v60, v60, v14
    v_sub_f32 v61, v61, v14
    v_mul_f32 v56, v56, v13
    v_mul_f32 v57, v57, v13
    v_mul_f32 v58, v58, v13
    v_mul_f32 v59, v59, v13
    v_mul_f32 v60, v60, v13
    v_mul_f32 v61, v61, v13
    v_cvt_pk_bf16_f32 v8, v56, v57
    v_cvt_pk_bf16_f32 v9, v58, v59
    v_cvt_pk_bf16_f32 v10, v60, v61
    v_mov_b32 v11, s50
    s_lshl_b32 s36, s35, 4
    s_add_u32 s36, s36, s34
    s_lshl_b32 s36, s36, 7
    s_add_u32 s36, s36, 65536
    v_add_u32 v3, s36, v223
    v_cmp_gt_u32 vcc, 8, v216
    s_and_saveexec_b64 s[62:63], vcc
    global_store_dwordx4 v3, v[8:11], s[8:9] sc1
    s_mov_b64 exec, s[62:63]
RF_48:
    s_branch K_FIN
TR_42:
    s_cmp_eq_u32 s52, 3
    s_cbranch_scc1 TG_43
    s_cmp_eq_u32 s52, 4
    s_cbranch_scc0 K_FIN
TG_43:
    s_cmp_eq_u32 s52, 3
    s_cbranch_scc1 GL1_51
    s_cmp_eq_u32 s52, 4
    s_cbranch_scc0 GLD_52
    v_lshrrev_b32 v1, 2, v216
    s_mul_i32 s34, s16, 96
    v_add_u32 v1, s34, v1
    v_and_b32 v128, 3, v216
    v_lshlrev_b32 v128, 4, v128
    s_lshl_b32 s34, s53, 6
    v_add_u32 v128, s34, v128
    v_add_u32 v2, 0, v1
    v_mul_u32_u24 v2, 768, v2
    v_add_u32 v2, v2, v128
    v_add_u32 v3, 16, v1
    v_mul_u32_u24 v3, 768, v3
    v_add_u32 v3, v3, v128
    v_add_u32 v4, 32, v1
    v_mul_u32_u24 v4, 768, v4
    v_add_u32 v4, v4, v128
    v_add_u32 v5, 48, v1
    v_mul_u32_u24 v5, 768, v5
    v_add_u32 v5, v5, v128
    v_add_u32 v6, 64, v1
    v_mul_u32_u24 v6, 768, v6
    v_add_u32 v6, v6, v128
    v_add_u32 v7, 80, v1
    v_mul_u32_u24 v7, 768, v7
    v_add_u32 v7, v7, v128
    global_load_dwordx4 v[68:71], v2, s[70:71]
    global_load_dwordx4 v[72:75], v3, s[70:71]
    global_load_dwordx4 v[76:79], v4, s[70:71]
    global_load_dwordx4 v[80:83], v5, s[70:71]
    global_load_dwordx4 v[84:87], v6, s[70:71]
    global_load_dwordx4 v[88:91], v7, s[70:71]
    v_and_b32 v1, 15, v216
    v_mul_u32_u24 v1, 768, v1
    v_lshrrev_b32 v2, 4, v216
    v_lshlrev_b32 v2, 4, v2
    s_lshl_b32 s34, s53, 6
    v_add3_u32 v252, v1, v2, s34
    global_load_dwordx4 v[248:251], v252, s[54:55]
    s_branch GLD_52
GL1_51:
    v_lshrrev_b32 v1, 2, v216
    s_mul_i32 s34, s16, 96
    v_add_u32 v1, s34, v1
    v_and_b32 v128, 3, v216
    v_lshlrev_b32 v128, 4, v128
    s_lshl_b32 s34, s53, 6
    v_add_u32 v128, s34, v128
    v_lshrrev_b32 v129, 2, v216
    v_add_u32 v129, 0, v129
    v_bfe_u32 v130, v129, 1, 2
    v_cmp_eq_u32 vcc, 3, v130
    v_lshlrev_b32 v130, 7, v130
    v_add_u32 v130, 0, v130
    v_mov_b32 v131, 96
    v_cndmask_b32 v130, v130, v131, vcc
    v_lshrrev_b32 v131, 3, v129
    v_lshlrev_b32 v131, 3, v131
    v_and_b32 v129, 1, v129
    v_add3_u32 v130, v130, v131, v129
    s_lshl_b32 s35, s16, 1
    v_add_u32 v2, s35, v130
    v_mul_u32_u24 v2, 768, v2
    v_add_u32 v2, v2, v128
    v_lshrrev_b32 v129, 2, v216
    v_add_u32 v129, 16, v129
    v_bfe_u32 v130, v129, 1, 2
    v_cmp_eq_u32 vcc, 3, v130
    v_lshlrev_b32 v130, 7, v130
    v_add_u32 v130, 0, v130
    v_mov_b32 v131, 96
    v_cndmask_b32 v130, v130, v131, vcc
    v_lshrrev_b32 v131, 3, v129
    v_lshlrev_b32 v131, 3, v131
    v_and_b32 v129, 1, v129
    v_add3_u32 v130, v130, v131, v129
    s_lshl_b32 s35, s16, 1
    v_add_u32 v3, s35, v130
    v_mul_u32_u24 v3, 768, v3
    v_add_u32 v3, v3, v128
    v_lshrrev_b32 v129, 2, v216
    v_add_u32 v129, 0, v129
    v_bfe_u32 v130, v129, 1, 2
    v_cmp_eq_u32 vcc, 3, v130
    v_lshlrev_b32 v130, 7, v130
    v_add_u32 v130, 32, v130
    v_mov_b32 v131, 224
    v_cndmask_b32 v130, v130, v131, vcc
    v_lshrrev_b32 v131, 3, v129
    v_lshlrev_b32 v131, 3, v131
    v_and_b32 v129, 1, v129
    v_add3_u32 v130, v130, v131, v129
    s_lshl_b32 s35, s16, 1
    v_add_u32 v4, s35, v130
    v_mul_u32_u24 v4, 768, v4
    v_add_u32 v4, v4, v128
    v_lshrrev_b32 v129, 2, v216
    v_add_u32 v129, 16, v129
    v_bfe_u32 v130, v129, 1, 2
    v_cmp_eq_u32 vcc, 3, v130
    v_lshlrev_b32 v130, 7, v130
    v_add_u32 v130, 32, v130
    v_mov_b32 v131, 224
    v_cndmask_b32 v130, v130, v131, vcc
    v_lshrrev_b32 v131, 3, v129
    v_lshlrev_b32 v131, 3, v131
    v_and_b32 v129, 1, v129
    v_add3_u32 v130, v130, v131, v129
    s_lshl_b32 s35, s16, 1
    v_add_u32 v5, s35, v130
    v_mul_u32_u24 v5, 768, v5
    v_add_u32 v5, v5, v128
    v_lshrrev_b32 v129, 2, v216
    v_add_u32 v129, 0, v129
    v_bfe_u32 v130, v129, 1, 2
    v_cmp_eq_u32 vcc, 3, v130
    v_lshlrev_b32 v130, 7, v130
    v_add_u32 v130, 64, v130
    v_mov_b32 v131, 352
    v_cndmask_b32 v130, v130, v131, vcc
    v_lshrrev_b32 v131, 3, v129
    v_lshlrev_b32 v131, 3, v131
    v_and_b32 v129, 1, v129
    v_add3_u32 v130, v130, v131, v129
    s_lshl_b32 s35, s16, 1
    v_add_u32 v6, s35, v130
    v_mul_u32_u24 v6, 768, v6
    v_add_u32 v6, v6, v128
    v_lshrrev_b32 v129, 2, v216
    v_add_u32 v129, 16, v129
    v_bfe_u32 v130, v129, 1, 2
    v_cmp_eq_u32 vcc, 3, v130
    v_lshlrev_b32 v130, 7, v130
    v_add_u32 v130, 64, v130
    v_mov_b32 v131, 352
    v_cndmask_b32 v130, v130, v131, vcc
    v_lshrrev_b32 v131, 3, v129
    v_lshlrev_b32 v131, 3, v131
    v_and_b32 v129, 1, v129
    v_add3_u32 v130, v130, v131, v129
    s_lshl_b32 s35, s16, 1
    v_add_u32 v7, s35, v130
    v_mul_u32_u24 v7, 768, v7
    v_add_u32 v7, v7, v128
    global_load_dwordx4 v[68:71], v2, s[68:69]
    global_load_dwordx4 v[72:75], v3, s[68:69]
    global_load_dwordx4 v[76:79], v4, s[68:69]
    global_load_dwordx4 v[80:83], v5, s[68:69]
    global_load_dwordx4 v[84:87], v6, s[68:69]
    global_load_dwordx4 v[88:91], v7, s[68:69]
GLD_52:
    s_waitcnt vmcnt(0)
    s_mul_i32 s34, s16, 12288
    s_add_u32 s34, s34, 0
    v_add_u32 v1, s34, v223
    ds_write_b128 v1, v[68:71] offset:0
    ds_write_b128 v1, v[72:75] offset:1024
    ds_write_b128 v1, v[76:79] offset:2048
    ds_write_b128 v1, v[80:83] offset:3072
    ds_write_b128 v1, v[84:87] offset:4096
    ds_write_b128 v1, v[88:91] offset:5120
    v_lshrrev_b32 v2, 4, v216
    v_lshlrev_b32 v2, 9, v2
    v_bfe_u32 v3, v216, 2, 2
    v_lshlrev_b32 v3, 6, v3
    v_and_b32 v4, 3, v216
    v_lshlrev_b32 v4, 4, v4
    v_add3_u32 v2, v2, v3, v4
    v_add_u32 v2, s34, v2
    ds_read_b64_tr_b16 a[156:157], v2 offset:0
    ds_read_b64_tr_b16 a[158:159], v2 offset:256
    ds_read_b64_tr_b16 a[160:161], v2 offset:8
    ds_read_b64_tr_b16 a[162:163], v2 offset:264
    ds_read_b64_tr_b16 a[164:165], v2 offset:2048
    ds_read_b64_tr_b16 a[166:167], v2 offset:2304
    ds_read_b64_tr_b16 a[168:169], v2 offset:2056
    ds_read_b64_tr_b16 a[170:171], v2 offset:2312
    ds_read_b64_tr_b16 a[172:173], v2 offset:4096
    ds_read_b64_tr_b16 a[174:175], v2 offset:4352
    ds_read_b64_tr_b16 a[176:177], v2 offset:4104
    ds_read_b64_tr_b16 a[178:179], v2 offset:4360
    s_cmp_eq_u32 s52, 4
    s_cbranch_scc1 G2_49
    s_lshl_b32 s34, s16, 12
    s_add_u32 s34, s34, 65536
    v_and_b32 v1, 15, v216
    v_lshlrev_b32 v1, 7, v1
    v_lshrrev_b32 v2, 4, v216
    v_lshlrev_b32 v2, 4, v2
    v_add3_u32 v222, v1, v2, s34
G4L_53:
    global_load_dwordx4 v[224:227], v222, s[8:9] offset:0 sc1
    global_load_dwordx4 v[228:231], v222, s[8:9] offset:64 sc1
    global_load_dwordx4 v[232:235], v222, s[8:9] offset:2048 sc1
    global_load_dwordx4 v[236:239], v222, s[8:9] offset:2112 sc1
    s_waitcnt vmcnt(0)
    v_xor_b32 v128, s50, v227
    v_xor_b32 v129, s50, v231
    v_xor_b32 v130, s50, v235
    v_xor_b32 v131, s50, v239
    v_or3_b32 v128, v128, v129, v130
    v_or_b32 v128, v128, v131
    v_cmp_ne_u32 vcc, 0, v128
    s_cbranch_vccz G4D_54
    s_add_u32 s60, s60, 1
    s_cmp_lt_u32 s60, 65536
    s_cbranch_scc0 K_END
    s_branch G4L_53
G4D_54:
    v_mov_b32 v227, v236
    v_mov_b32 v231, v237
    v_mov_b32 v235, v238
    s_waitcnt lgkmcnt(0)
    v_mfma_f32_16x16x32_bf16 v[184:187], a[156:159], v[224:227], 0
    v_mfma_f32_16x16x32_bf16 v[188:191], a[160:163], v[224:227], 0
    v_mfma_f32_16x16x32_bf16 v[184:187], a[164:167], v[228:231], v[184:187]
    v_mfma_f32_16x16x32_bf16 v[188:191], a[168:171], v[228:231], v[188:191]
    v_mfma_f32_16x16x32_bf16 v[184:187], a[172:175], v[232:235], v[184:187]
    v_mfma_f32_16x16x32_bf16 v[188:191], a[176:179], v[232:235], v[188:191]
    s_branch GJ_50
G2_49:
    s_mul_i32 s34, s16, 6144
    s_add_u32 s34, s34, 395264
    v_add_u32 v222, s34, v223
GL_55:
    s_mov_b32 s37, 0
GI_56:
    global_load_dwordx4 v[224:227], v222, s[8:9] offset:-2048 sc1
    global_load_dwordx4 v[228:231], v222, s[8:9] offset:-1024 sc1
    global_load_dwordx4 v[232:235], v222, s[8:9] offset:0 sc1
    global_load_dwordx4 v[236:239], v222, s[8:9] offset:1024 sc1
    global_load_dwordx4 v[240:243], v222, s[8:9] offset:2048 sc1
    global_load_dwordx4 v[244:247], v222, s[8:9] offset:3072 sc1
    s_waitcnt vmcnt(0)
    v_xor_b32 v128, s50, v224
    v_xor_b32 v129, s50, v230
    v_xor_b32 v130, s50, v232
    v_xor_b32 v131, s50, v238
    v_xor_b32 v132, s50, v240
    v_xor_b32 v133, s50, v246
    v_or3_b32 v128, v128, v129, v130
    v_or3_b32 v131, v131, v132, v133
    v_or_b32 v128, v128, v131
    v_cmp_ne_u32 vcc, 0, v128
    s_cbranch_vccz GD_57
    s_add_u32 s37, s37, 1
    s_cmp_lt_u32 s37, 16
    s_cbranch_scc1 GI_56
    v_add_u32 v222, 4294672384, v222
    global_load_dwordx4 v[224:227], v222, s[8:9] offset:-2048 sc1
    global_load_dwordx4 v[228:231], v222, s[8:9] offset:-1024 sc1
    global_load_dwordx4 v[232:235], v222, s[8:9] offset:0 sc1
    global_load_dwordx4 v[236:239], v222, s[8:9] offset:1024 sc1
    global_load_dwordx4 v[240:243], v222, s[8:9] offset:2048 sc1
    global_load_dwordx4 v[244:247], v222, s[8:9] offset:3072 sc1
    v_subrev_u32 v222, 4294672384, v222
    s_waitcnt vmcnt(0)
    v_xor_b32 v128, s50, v224
    v_xor_b32 v129, s50, v230
    v_xor_b32 v130, s50, v232
    v_xor_b32 v131, s50, v238
    v_xor_b32 v132, s50, v240
    v_xor_b32 v133, s50, v246
    v_or3_b32 v128, v128, v129, v130
    v_or3_b32 v131, v131, v132, v133
    v_or_b32 v128, v128, v131
    v_cmp_ne_u32 vcc, 0, v128
    s_cbranch_vccz GD_57
    s_add_u32 s60, s60, 1
    s_cmp_lt_u32 s60, 65536
    s_cbranch_scc0 K_END
    s_branch GL_55
GD_57:
    s_waitcnt lgkmcnt(0)
    v_mfma_f32_16x16x32_bf16 v[184:187], a[156:159], v[226:229], 0
    v_mfma_f32_16x16x32_bf16 v[188:191], a[160:163], v[226:229], 0
    v_mfma_f32_16x16x32_bf16 v[184:187], a[164:167], v[234:237], v[184:187]
    v_mfma_f32_16x16x32_bf16 v[188:191], a[168:171], v[234:237], v[188:191]
    v_mfma_f32_16x16x32_bf16 v[184:187], a[172:175], v[242:245], v[184:187]
    v_mfma_f32_16x16x32_bf16 v[188:191], a[176:179], v[242:245], v[188:191]
GJ_50:
    s_nop 7
    s_cmp_eq_u32 s16, 0
    s_cbranch_scc1 XW0_59
    s_sub_u32 s34, s16, 1
    s_lshl_b32 s34, s34, 11
    s_add_u32 s34, s34, 53760
    v_add_u32 v1, s34, v223
    ds_write_b128 v1, v[184:187]
    ds_write_b128 v1, v[188:191] offset:1024
    s_waitcnt lgkmcnt(0)
XW0_59:
    s_barrier
    s_cmp_eq_u32 s16, 0
    s_cbranch_scc0 XW_58
    v_add_u32 v1, 53760, v223
    ds_read_b128 v[128:131], v1 offset:0
    ds_read_b128 v[132:135], v1 offset:1024
    ds_read_b128 v[136:139], v1 offset:2048
    ds_read_b128 v[140:143], v1 offset:3072
    ds_read_b128 v[144:147], v1 offset:4096
    ds_read_b128 v[148:151], v1 offset:5120
    s_waitcnt lgkmcnt(4)
    v_add_f32 v184, v184, v128
    v_add_f32 v185, v185, v129
    v_add_f32 v186, v186, v130
    v_add_f32 v187, v187, v131
    v_add_f32 v188, v188, v132
    v_add_f32 v189, v189, v133
    v_add_f32 v190, v190, v134
    v_add_f32 v191, v191, v135
    s_waitcnt lgkmcnt(2)
    v_add_f32 v184, v184, v136
    v_add_f32 v185, v185, v137
    v_add_f32 v186, v186, v138
    v_add_f32 v187, v187, v139
    v_add_f32 v188, v188, v140
    v_add_f32 v189, v189, v141
    v_add_f32 v190, v190, v142
    v_add_f32 v191, v191, v143
    s_waitcnt lgkmcnt(0)
    v_add_f32 v184, v184, v144
    v_add_f32 v185, v185, v145
    v_add_f32 v186, v186, v146
    v_add_f32 v187, v187, v147
    v_add_f32 v188, v188, v148
    v_add_f32 v189, v189, v149
    v_add_f32 v190, v190, v150
    v_add_f32 v191, v191, v151
    s_cmp_eq_u32 s52, 4
    s_cbranch_scc1 GO_60
    v_cvt_pk_bf16_f32 v10, v184, v185
    v_cvt_pk_bf16_f32 v11, v186, v187
    v_cvt_pk_bf16_f32 v12, v188, v189
    v_cvt_pk_bf16_f32 v13, v190, v191
    s_lshl_b32 s34, s53, 11
    s_add_u32 s34, s34, 393216
    v_mov_b32 v8, s50
    v_mov_b32 v9, 0
    v_mov_b32 v14, s50
    v_mov_b32 v15, 0
    v_add_u32 v1, s34, v223
    v_add_u32 v2, 4294672384, v1
    global_store_dwordx4 v1, v[8:11], s[8:9]
    global_store_dwordx4 v1, v[12:15], s[8:9] offset:1024
    global_store_dwordx4 v2, v[8:11], s[8:9] sc1
    global_store_dwordx4 v2, v[12:15], s[8:9] offset:1024 sc1
    s_branch XW_58
GO_60:
    v_lshlrev_b32 v8, 16, v248
    v_and_b32 v9, 0xffff0000, v248
    v_add_f32 v8, v8, v184
    v_add_f32 v9, v9, v185
    v_cvt_pk_bf16_f32 v12, v8, v9
    v_lshlrev_b32 v8, 16, v249
    v_and_b32 v9, 0xffff0000, v249
    v_add_f32 v8, v8, v186
    v_add_f32 v9, v9, v187
    v_cvt_pk_bf16_f32 v13, v8, v9
    v_lshlrev_b32 v8, 16, v250
    v_and_b32 v9, 0xffff0000, v250
    v_add_f32 v8, v8, v188
    v_add_f32 v9, v9, v189
    v_cvt_pk_bf16_f32 v14, v8, v9
    v_lshlrev_b32 v8, 16, v251
    v_and_b32 v9, 0xffff0000, v251
    v_add_f32 v8, v8, v190
    v_add_f32 v9, v9, v191
    v_cvt_pk_bf16_f32 v15, v8, v9
    global_store_dwordx4 v252, v[12:15], s[58:59]
    s_cmp_eq_u32 s53, 0
    s_cbranch_scc0 XW_58
    s_add_u32 s34, s51, 1
    v_mov_b32 v8, s34
    v_mov_b32 v9, 0
    v_cmp_eq_u32 vcc, 0, v216
    s_and_saveexec_b64 s[62:63], vcc
    global_store_dword v9, v8, s[8:9]
    s_mov_b64 exec, s[62:63]
XW_58:
K_FIN:
K_END:
    s_endpgm
.section .rodata,"a"
.p2align 6
.amdhsa_kernel standalone__detection_seg_dino__vision_kernel
  .amdhsa_next_free_vgpr 436
  .amdhsa_next_free_sgpr 96
  .amdhsa_accum_offset 256
  .amdhsa_group_segment_fixed_size 0
  .amdhsa_kernarg_size 80
  .amdhsa_user_sgpr_count 2
  .amdhsa_user_sgpr_kernarg_segment_ptr 1
  .amdhsa_system_sgpr_workgroup_id_x 1
  .amdhsa_float_denorm_mode_32 3
.end_amdhsa_kernel
```
